```python
import torch

def _softmax(x, axis=-1):
    return torch.softmax(x, dim=axis)
def _gelu(x):
    return torch.nn.functional.gelu(x, approximate="tanh")
def _silu(x):
    return torch.nn.functional.silu(x)
def _sigmoid(x):
    return torch.sigmoid(x)
def _layernorm(x, axis=-1, eps=1e-5):
    m = x.mean(dim=axis, keepdim=True)
    v = x.var(dim=axis, keepdim=True, unbiased=False)
    return (x - m) / torch.sqrt(v + eps)
def _scatter_add(tgt, idx, src, axis=0):
    return tgt.clone().index_add_(axis, idx, src)
def _segment_sum(src, seg, n):
    out = torch.zeros((n,) + src.shape[1:], dtype=src.dtype)
    return out.index_add_(0, seg, src)
def _pad(x, pw):
    flat = tuple(v for pair in reversed(pw) for v in pair)
    return torch.nn.functional.pad(x, flat)

kernel_name = 'standalone__edge_featured_mpnn_mpnn__graph'

def setup_inputs():

    _w = (lambda a: (lambda t: t.to(torch.bfloat16) if t.is_floating_point() else t)(torch.as_tensor(a)))
    N, deg, D, De = 10000, 16, 256, max(0, 1)
    E = N * deg
    H = 2 * D
    return {
        "x": _w((lambda *s: torch.randn(*s, dtype=torch.bfloat16) * 0.05)(N, D)),
        "e_attr": _w((lambda *s: torch.randn(*s, dtype=torch.bfloat16) * 1.6)(E, De)),
        "src": _w((lambda lo, hi, *s: torch.randint(lo, hi, s))(0, N, E).to(torch.int64)),
        "dst": _w((lambda lo, hi, *s: torch.randint(lo, hi, s))(0, N, E).to(torch.int64)),
        "w1": _w((lambda *s: torch.randn(*s, dtype=torch.bfloat16) * 1.6)(2 * D + De, H) * (1.0 / (2 * D + De) ** 0.5)),
        "b1": _w((lambda *s: torch.randn(*s, dtype=torch.bfloat16) * 0.8)(H) * 0.01),
        "w2": _w((lambda *s: torch.randn(*s, dtype=torch.bfloat16) * 0.05)(H, D) * (1.0 / H ** 0.5)),
        "b2": _w((lambda *s: torch.randn(*s, dtype=torch.bfloat16) * 0.05)(D) * 0.01),
    }

def reference(x, e_attr, src, dst, w1, b1, w2, b2):
    N, D = x.shape
    h_src = x[src]
    h_dst = x[dst]
    m_in = torch.concatenate([h_src, h_dst, e_attr], axis=-1)
    h = _silu(m_in @ w1 + b1)
    msg = h @ w2 + b2
    return _segment_sum(msg, dst, N)
```

```asm
; @launch kernel=mpnn_prep_kernel grid=(256,1,1) block=(512,1,1) lds=163840
; @launch kernel=mpnn_edge_kernel grid=(256,1,1) block=(512,1,1) lds=140032
.amdgcn_target "amdgcn-amd-amdhsa--gfx950"
.text
.globl mpnn_prep_kernel
.p2align 8
.type mpnn_prep_kernel,@function
mpnn_prep_kernel:
mpnn_code_begin:
  s_cmp_ge_u32 s2, 256
  s_cbranch_scc1 k1_exit
  s_load_dwordx16 s[4:19], s[0:1], 0
  s_load_dwordx4 s[20:23], s[0:1], 64
  s_load_dwordx2 s[24:25], s[0:1], 80
  v_readfirstlane_b32 s26, v0
  v_and_b32 v1, 63, v0
  s_lshr_b32 s26, s26, 6
  s_and_b32 s27, s2, 7
  s_lshr_b32 s3, s2, 3
  s_cmp_ge_u32 s3, 5
  s_cbranch_scc1 k1_gemm
  s_cmp_lt_u32 s3, 4
  s_cbranch_scc1 k1_sort
  s_getpc_b64 s[40:41]
k1_pc:
  s_sub_u32 s40, s40, k1_pc-mpnn_code_begin
  s_subb_u32 s41, s41, 0
  v_lshlrev_b32 v46, 7, v0
  v_min_u32 v46, mpnn_code_end-mpnn_code_begin-4, v46
  v_mov_b32 v47, s41
  v_add_co_u32 v46, vcc, s40, v46
  s_nop 1
  v_addc_co_u32 v47, vcc, 0, v47, vcc
  global_load_dword v48, v[46:47], off
  s_branch k1_prep
k1_gemm:
  s_mul_i32 s54, s27, 27
  s_add_u32 s3, s3, s54
  s_sub_u32 s3, s3, 5
  s_and_b32 s46, s3, 7
  s_lshr_b32 s3, s3, 3
  s_mul_i32 s44, s3, 189991
  s_add_u32 s45, s44, 189991
  s_lshr_b32 s44, s44, 14
  s_lshr_b32 s45, s45, 14
  s_sub_u32 s45, s45, s44
  s_and_b32 s47, s26, 1
  s_lshr_b32 s48, s26, 1
  s_lshr_b32 s54, s46, 2
  s_lshl_b32 s49, s54, 18
  s_and_b32 s55, s46, 3
  s_lshl_b32 s55, s55, 8
  s_add_u32 s49, s49, s55
  s_lshl_b32 s55, s26, 14
  s_add_u32 s49, s49, s55
  v_lshrrev_b32 v16, 4, v1
  v_and_b32 v17, 15, v1
  v_lshlrev_b32 v18, 1, v16
  v_xor_b32 v18, v17, v18
  v_lshlrev_b32 v18, 4, v18
  v_lshl_add_u32 v2, v16, 10, v18
  v_xor_b32 v3, 128, v2
  s_lshl_b32 s55, s26, 2
  v_add_u32 v18, s55, v16
  v_xor_b32 v19, v18, v1
  v_and_b32 v19, 15, v19
  v_lshlrev_b32 v19, 4, v19
  v_lshl_add_u32 v4, v18, 9, v19
  v_add_u32 v5, 256, v4
  s_lshl_b32 s62, s26, 12
  s_lshl_b32 s52, s26, 10
  s_lshl_b32 s53, s44, 14
  s_waitcnt lgkmcnt(0)
  s_mov_b32 s32, s12
  s_mov_b32 s33, s13
  s_mov_b32 s34, 525312
  s_mov_b32 s35, 0x00020000
  s_add_u32 m0, s62, 0
  s_add_u32 s54, s49, 0
  buffer_load_dwordx4 v2, s[32:35], s54 offen lds
  s_add_u32 m0, s62, 1024
  s_add_u32 s54, s49, 4096
  buffer_load_dwordx4 v2, s[32:35], s54 offen lds
  s_add_u32 m0, s62, 2048
  s_add_u32 s54, s49, 8192
  buffer_load_dwordx4 v3, s[32:35], s54 offen lds
  s_add_u32 m0, s62, 3072
  s_add_u32 s54, s49, 12288
  buffer_load_dwordx4 v3, s[32:35], s54 offen lds
  s_mov_b32 s28, s4
  s_mov_b32 s29, s5
  s_mov_b32 s30, 5120000
  s_mov_b32 s31, 0x00020000
  s_add_u32 m0, s52, 65536
  s_add_u32 s54, s53, 0
  buffer_load_dwordx4 v4, s[28:31], s54 offen lds
  s_add_u32 m0, s52, 81920
  s_add_u32 s54, s53, 16384
  buffer_load_dwordx4 v4, s[28:31], s54 offen lds
  s_add_u32 m0, s52, 98304
  s_add_u32 s54, s53, 32768
  buffer_load_dwordx4 v4, s[28:31], s54 offen lds
  s_add_u32 m0, s52, 114688
  s_add_u32 s54, s53, 49152
  buffer_load_dwordx4 v4, s[28:31], s54 offen lds
  s_add_u32 m0, s62, 32768
  s_add_u32 s54, s49, 131072
  buffer_load_dwordx4 v2, s[32:35], s54 offen lds
  s_add_u32 m0, s52, 73728
  s_add_u32 s54, s53, 0
  buffer_load_dwordx4 v5, s[28:31], s54 offen lds
  s_add_u32 m0, s62, 33792
  s_add_u32 s54, s49, 135168
  buffer_load_dwordx4 v2, s[32:35], s54 offen lds
  s_add_u32 m0, s52, 90112
  s_add_u32 s54, s53, 16384
  buffer_load_dwordx4 v5, s[28:31], s54 offen lds
  s_add_u32 m0, s62, 34816
  s_add_u32 s54, s49, 139264
  buffer_load_dwordx4 v3, s[32:35], s54 offen lds
  s_add_u32 m0, s52, 106496
  s_add_u32 s54, s53, 32768
  buffer_load_dwordx4 v5, s[28:31], s54 offen lds
  s_add_u32 m0, s62, 35840
  s_add_u32 s54, s49, 143360
  buffer_load_dwordx4 v3, s[32:35], s54 offen lds
  s_add_u32 m0, s52, 122880
  s_add_u32 s54, s53, 49152
  buffer_load_dwordx4 v5, s[28:31], s54 offen lds
  s_add_u32 s53, s53, 65536
  s_mov_b32 s40, s14
  s_mov_b32 s41, s15
  s_mov_b32 s42, 1024
  s_mov_b32 s43, 0x00020000
  s_lshl_b32 s54, s46, 1
  s_add_u32 s54, s54, s47
  s_mul_i32 s55, s54, 1310720
  s_and_b32 s54, s54, 7
  s_lshl_b32 s54, s54, 7
  v_lshlrev_b32 v18, 1, v17
  s_mov_b32 s50, 0xbfb8aa3b
  s_cmp_ge_u32 s46, 4
  s_cselect_b32 s42, 1024, 0
  buffer_load_ushort v12, v18, s[40:43], s54 offen offset:0
  buffer_load_ushort v13, v18, s[40:43], s54 offen offset:32
  buffer_load_ushort v14, v18, s[40:43], s54 offen offset:64
  buffer_load_ushort v15, v18, s[40:43], s54 offen offset:96
  s_add_u32 s36, s24, s55
  s_addc_u32 s37, s25, 0
  s_mov_b32 s38, 1280000
  s_mov_b32 s39, 0x00020000
  v_bfe_u32 v18, v1, 2, 2
  v_lshl_add_u32 v19, v16, 3, v18
  v_lshlrev_b32 v19, 8, v19
  v_and_b32 v6, 3, v1
  v_lshl_add_u32 v19, v6, 3, v19
  v_bfe_u32 v6, v1, 4, 1
  v_xor_b32 v6, s47, v6
  v_lshl_add_u32 v18, v6, 2, v18
  v_lshl_add_u32 v6, v18, 5, v19
  v_xor_b32 v7, 32, v6
  v_xor_b32 v8, 64, v6
  v_xor_b32 v9, 96, v6
  v_xor_b32 v18, v17, v16
  v_lshlrev_b32 v18, 4, v18
  v_lshl_add_u32 v10, v17, 8, v18
  v_lshlrev_b32 v18, 3, v17
  v_lshl_add_u32 v11, v16, 9, v18
  s_cmp_lt_u32 s48, 2
  s_mov_b32 s55, 65536
  s_cselect_b32 s56, 65536, s55
  s_lshl_b32 s54, s48, 14
  s_add_u32 s56, s56, s54
  s_add_u32 s54, s44, s48
  s_add_u32 s54, s54, 0
  s_lshl_b32 s59, s54, 12
  s_cmp_lt_u32 s48, 2
  s_mov_b32 s55, 4294934528
  s_cselect_b32 s57, 131072, s55
  s_lshl_b32 s54, s48, 14
  s_add_u32 s57, s57, s54
  s_add_u32 s54, s44, s48
  s_add_u32 s54, s54, 4
  s_lshl_b32 s60, s54, 12
  s_cmp_lt_u32 s48, 2
  s_mov_b32 s55, 32768
  s_cselect_b32 s58, 32768, s55
  s_lshl_b32 s54, s48, 14
  s_add_u32 s58, s58, s54
  s_add_u32 s54, s44, s48
  s_add_u32 s54, s54, 8
  s_lshl_b32 s61, s54, 12
  v_add_u32 v20, s56, v10
  v_xor_b32 v21, 64, v20
  v_xor_b32 v22, 128, v20
  v_xor_b32 v23, 192, v20
  s_lshl_b32 s55, s46, 3
  s_add_u32 s55, s55, s26
  s_mul_i32 s55, s55, 1536
  s_add_u32 s55, s55, s53
  s_add_u32 s55, s55, 32768
  v_min_u32 v19, 11, v1
  v_lshlrev_b32 v19, 7, v19
  s_cmp_ge_u32 s26, 4
  s_cselect_b64 vcc, -1, 0
  s_waitcnt vmcnt(12)
  s_barrier
  ds_read_b64_tr_b16 v[104:105], v6 offset:0
  ds_read_b64_tr_b16 v[106:107], v6 offset:1024
  ds_read_b64_tr_b16 v[108:109], v7 offset:0
  ds_read_b64_tr_b16 v[110:111], v7 offset:1024
  ds_read_b64_tr_b16 v[112:113], v8 offset:0
  ds_read_b64_tr_b16 v[114:115], v8 offset:1024
  ds_read_b64_tr_b16 v[116:117], v9 offset:0
  ds_read_b64_tr_b16 v[118:119], v9 offset:1024
  ds_read_b128 v[24:27], v20 offset:0
  ds_read_b128 v[28:31], v20 offset:4096
  s_waitcnt lgkmcnt(1)
  v_mfma_f32_16x16x32_bf16 v[40:43], v[24:27], v[104:107], 0
  ds_read_b64_tr_b16 v[120:121], v6 offset:8192
  v_mfma_f32_16x16x32_bf16 v[44:47], v[24:27], v[108:111], 0
  ds_read_b64_tr_b16 v[122:123], v6 offset:9216
  v_mfma_f32_16x16x32_bf16 v[48:51], v[24:27], v[112:115], 0
  ds_read_b64_tr_b16 v[124:125], v7 offset:8192
  v_mfma_f32_16x16x32_bf16 v[52:55], v[24:27], v[116:119], 0
  ds_read_b64_tr_b16 v[126:127], v7 offset:9216
  ds_read_b128 v[32:35], v21 offset:0
  s_cbranch_vccnz k1_skip1
  buffer_load_dword v19, v19, s[28:31], s55 offen
  s_add_u32 m0, s52, 131072
  s_nop 0
  buffer_load_dwordx4 v4, s[28:31], s53 offen lds
k1_skip1:
  s_waitcnt lgkmcnt(5)
  v_mfma_f32_16x16x32_bf16 v[56:59], v[28:31], v[104:107], 0
  ds_read_b64_tr_b16 v[128:129], v8 offset:8192
  v_mfma_f32_16x16x32_bf16 v[60:63], v[28:31], v[108:111], 0
  ds_read_b64_tr_b16 v[130:131], v8 offset:9216
  v_mfma_f32_16x16x32_bf16 v[64:67], v[28:31], v[112:115], 0
  ds_read_b64_tr_b16 v[132:133], v9 offset:8192
  v_mfma_f32_16x16x32_bf16 v[68:71], v[28:31], v[116:119], 0
  ds_read_b64_tr_b16 v[134:135], v9 offset:9216
  ds_read_b128 v[36:39], v21 offset:4096
  s_cbranch_vccz k1_skip2
  buffer_load_dword v19, v19, s[28:31], s55 offen
  s_add_u32 m0, s52, 131072
  s_nop 0
  buffer_load_dwordx4 v4, s[28:31], s53 offen lds
k1_skip2:
  s_waitcnt lgkmcnt(1)
  v_mfma_f32_16x16x32_bf16 v[40:43], v[32:35], v[120:123], v[40:43]
  ds_read_b64_tr_b16 v[136:137], v6 offset:16384
  v_mfma_f32_16x16x32_bf16 v[44:47], v[32:35], v[124:127], v[44:47]
  ds_read_b64_tr_b16 v[138:139], v6 offset:17408
  v_mfma_f32_16x16x32_bf16 v[48:51], v[32:35], v[128:131], v[48:51]
  ds_read_b64_tr_b16 v[140:141], v7 offset:16384
  v_mfma_f32_16x16x32_bf16 v[52:55], v[32:35], v[132:135], v[52:55]
  ds_read_b64_tr_b16 v[142:143], v7 offset:17408
  ds_read_b128 v[24:27], v22 offset:0
  s_cbranch_vccnz k1_skip3
  s_add_u32 m0, s52, 139264
  s_nop 0
  buffer_load_dwordx4 v5, s[28:31], s53 offen lds
  s_add_u32 s53, s53, 16384
  s_add_u32 m0, s52, 147456
  s_nop 0
  buffer_load_dwordx4 v4, s[28:31], s53 offen lds
k1_skip3:
  s_waitcnt lgkmcnt(5)
  v_mfma_f32_16x16x32_bf16 v[56:59], v[36:39], v[120:123], v[56:59]
  ds_read_b64_tr_b16 v[144:145], v8 offset:16384
  v_mfma_f32_16x16x32_bf16 v[60:63], v[36:39], v[124:127], v[60:63]
  ds_read_b64_tr_b16 v[146:147], v8 offset:17408
  v_mfma_f32_16x16x32_bf16 v[64:67], v[36:39], v[128:131], v[64:67]
  ds_read_b64_tr_b16 v[148:149], v9 offset:16384
  v_mfma_f32_16x16x32_bf16 v[68:71], v[36:39], v[132:135], v[68:71]
  ds_read_b64_tr_b16 v[150:151], v9 offset:17408
  ds_read_b128 v[28:31], v22 offset:4096
  s_cbranch_vccz k1_skip4
  s_add_u32 m0, s52, 139264
  s_nop 0
  buffer_load_dwordx4 v5, s[28:31], s53 offen lds
  s_add_u32 s53, s53, 16384
  s_add_u32 m0, s52, 147456
  s_nop 0
  buffer_load_dwordx4 v4, s[28:31], s53 offen lds
k1_skip4:
  s_waitcnt lgkmcnt(1)
  v_mfma_f32_16x16x32_bf16 v[40:43], v[24:27], v[136:139], v[40:43]
  ds_read_b64_tr_b16 v[152:153], v6 offset:24576
  v_mfma_f32_16x16x32_bf16 v[44:47], v[24:27], v[140:143], v[44:47]
  ds_read_b64_tr_b16 v[154:155], v6 offset:25600
  v_mfma_f32_16x16x32_bf16 v[48:51], v[24:27], v[144:147], v[48:51]
  ds_read_b64_tr_b16 v[156:157], v7 offset:24576
  v_mfma_f32_16x16x32_bf16 v[52:55], v[24:27], v[148:151], v[52:55]
  ds_read_b64_tr_b16 v[158:159], v7 offset:25600
  ds_read_b128 v[32:35], v23 offset:0
  s_cbranch_vccnz k1_skip5
  s_add_u32 m0, s52, 155648
  s_nop 0
  buffer_load_dwordx4 v5, s[28:31], s53 offen lds
  s_add_u32 s53, s53, 16384
k1_skip5:
  s_waitcnt lgkmcnt(5)
  v_mfma_f32_16x16x32_bf16 v[56:59], v[28:31], v[136:139], v[56:59]
  ds_read_b64_tr_b16 v[160:161], v8 offset:24576
  v_mfma_f32_16x16x32_bf16 v[60:63], v[28:31], v[140:143], v[60:63]
  ds_read_b64_tr_b16 v[162:163], v8 offset:25600
  v_mfma_f32_16x16x32_bf16 v[64:67], v[28:31], v[144:147], v[64:67]
  ds_read_b64_tr_b16 v[164:165], v9 offset:24576
  v_mfma_f32_16x16x32_bf16 v[68:71], v[28:31], v[148:151], v[68:71]
  ds_read_b64_tr_b16 v[166:167], v9 offset:25600
  ds_read_b128 v[36:39], v23 offset:4096
  s_cbranch_vccz k1_skip6
  s_add_u32 m0, s52, 155648
  s_nop 0
  buffer_load_dwordx4 v5, s[28:31], s53 offen lds
  s_add_u32 s53, s53, 16384
k1_skip6:
  s_waitcnt vmcnt(5) lgkmcnt(0)
  s_barrier
  v_mfma_f32_16x16x32_bf16 v[40:43], v[32:35], v[152:155], v[40:43]
  ds_read_b64_tr_b16 v[168:169], v6 offset:32768
  v_mfma_f32_16x16x32_bf16 v[44:47], v[32:35], v[156:159], v[44:47]
  ds_read_b64_tr_b16 v[170:171], v6 offset:33792
  v_mfma_f32_16x16x32_bf16 v[48:51], v[32:35], v[160:163], v[48:51]
  ds_read_b64_tr_b16 v[172:173], v7 offset:32768
  v_mfma_f32_16x16x32_bf16 v[52:55], v[32:35], v[164:167], v[52:55]
  ds_read_b64_tr_b16 v[174:175], v7 offset:33792
  ds_read_b128 v[24:27], v20 offset:8192
  s_cbranch_vccnz k1_skip7
  s_add_u32 m0, s52, 0
  s_nop 0
  buffer_load_dwordx4 v4, s[28:31], s53 offen lds
  s_add_u32 m0, s52, 8192
  s_nop 0
  buffer_load_dwordx4 v5, s[28:31], s53 offen lds
  s_add_u32 s53, s53, 16384
k1_skip7:
  v_mfma_f32_16x16x32_bf16 v[56:59], v[36:39], v[152:155], v[56:59]
  ds_read_b64_tr_b16 v[176:177], v8 offset:32768
  v_mfma_f32_16x16x32_bf16 v[60:63], v[36:39], v[156:159], v[60:63]
  ds_read_b64_tr_b16 v[178:179], v8 offset:33792
  v_mfma_f32_16x16x32_bf16 v[64:67], v[36:39], v[160:163], v[64:67]
  ds_read_b64_tr_b16 v[180:181], v9 offset:32768
  v_mfma_f32_16x16x32_bf16 v[68:71], v[36:39], v[164:167], v[68:71]
  ds_read_b64_tr_b16 v[182:183], v9 offset:33792
  ds_read_b128 v[28:31], v20 offset:12288
  s_cbranch_vccz k1_skip8
  s_add_u32 m0, s52, 0
  s_nop 0
  buffer_load_dwordx4 v4, s[28:31], s53 offen lds
  s_add_u32 m0, s52, 8192
  s_nop 0
  buffer_load_dwordx4 v5, s[28:31], s53 offen lds
  s_add_u32 s53, s53, 16384
k1_skip8:
  s_waitcnt lgkmcnt(1)
  v_mfma_f32_16x16x32_bf16 v[40:43], v[24:27], v[168:171], v[40:43]
  ds_read_b64_tr_b16 v[184:185], v6 offset:40960
  v_mfma_f32_16x16x32_bf16 v[44:47], v[24:27], v[172:175], v[44:47]
  ds_read_b64_tr_b16 v[186:187], v6 offset:41984
  v_mfma_f32_16x16x32_bf16 v[48:51], v[24:27], v[176:179], v[48:51]
  ds_read_b64_tr_b16 v[188:189], v7 offset:40960
  v_mfma_f32_16x16x32_bf16 v[52:55], v[24:27], v[180:183], v[52:55]
  ds_read_b64_tr_b16 v[190:191], v7 offset:41984
  ds_read_b128 v[32:35], v21 offset:8192
  v_lshlrev_b32 v12, 16, v12
  v_mul_f32 v12, s50, v12
  v_lshlrev_b32 v13, 16, v13
  v_mul_f32 v13, s50, v13
  v_lshlrev_b32 v14, 16, v14
  v_mul_f32 v14, s50, v14
  v_lshlrev_b32 v15, 16, v15
  v_mul_f32 v15, s50, v15
  s_cbranch_vccnz k1_skip9
  s_add_u32 m0, s52, 16384
  s_nop 0
  buffer_load_dwordx4 v4, s[28:31], s53 offen lds
  s_add_u32 m0, s52, 24576
  s_nop 0
  buffer_load_dwordx4 v5, s[28:31], s53 offen lds
  s_add_u32 s53, s53, 16384
k1_skip9:
  s_waitcnt lgkmcnt(5)
  v_mfma_f32_16x16x32_bf16 v[56:59], v[28:31], v[168:171], v[56:59]
  ds_read_b64_tr_b16 v[192:193], v8 offset:40960
  v_mfma_f32_16x16x32_bf16 v[60:63], v[28:31], v[172:175], v[60:63]
  ds_read_b64_tr_b16 v[194:195], v8 offset:41984
  v_mfma_f32_16x16x32_bf16 v[64:67], v[28:31], v[176:179], v[64:67]
  ds_read_b64_tr_b16 v[196:197], v9 offset:40960
  v_mfma_f32_16x16x32_bf16 v[68:71], v[28:31], v[180:183], v[68:71]
  ds_read_b64_tr_b16 v[198:199], v9 offset:41984
  ds_read_b128 v[36:39], v21 offset:12288
  s_cbranch_vccz k1_skip10
  s_add_u32 m0, s52, 16384
  s_nop 0
  buffer_load_dwordx4 v4, s[28:31], s53 offen lds
  s_add_u32 m0, s52, 24576
  s_nop 0
  buffer_load_dwordx4 v5, s[28:31], s53 offen lds
  s_add_u32 s53, s53, 16384
k1_skip10:
  s_waitcnt lgkmcnt(1)
  v_mfma_f32_16x16x32_bf16 v[40:43], v[32:35], v[184:187], v[40:43]
  ds_read_b64_tr_b16 v[200:201], v6 offset:49152
  v_mfma_f32_16x16x32_bf16 v[44:47], v[32:35], v[188:191], v[44:47]
  ds_read_b64_tr_b16 v[202:203], v6 offset:50176
  v_mfma_f32_16x16x32_bf16 v[48:51], v[32:35], v[192:195], v[48:51]
  ds_read_b64_tr_b16 v[204:205], v7 offset:49152
  v_mfma_f32_16x16x32_bf16 v[52:55], v[32:35], v[196:199], v[52:55]
  ds_read_b64_tr_b16 v[206:207], v7 offset:50176
  ds_read_b128 v[24:27], v22 offset:8192
  s_waitcnt lgkmcnt(5)
  v_mfma_f32_16x16x32_bf16 v[56:59], v[36:39], v[184:187], v[56:59]
  ds_read_b64_tr_b16 v[208:209], v8 offset:49152
  v_mfma_f32_16x16x32_bf16 v[60:63], v[36:39], v[188:191], v[60:63]
  ds_read_b64_tr_b16 v[210:211], v8 offset:50176
  v_mfma_f32_16x16x32_bf16 v[64:67], v[36:39], v[192:195], v[64:67]
  ds_read_b64_tr_b16 v[212:213], v9 offset:49152
  v_mfma_f32_16x16x32_bf16 v[68:71], v[36:39], v[196:199], v[68:71]
  ds_read_b64_tr_b16 v[214:215], v9 offset:50176
  ds_read_b128 v[28:31], v22 offset:12288
  s_waitcnt lgkmcnt(1)
  v_mfma_f32_16x16x32_bf16 v[40:43], v[24:27], v[200:203], v[40:43]
  ds_read_b64_tr_b16 v[216:217], v6 offset:57344
  v_mfma_f32_16x16x32_bf16 v[44:47], v[24:27], v[204:207], v[44:47]
  ds_read_b64_tr_b16 v[218:219], v6 offset:58368
  v_mfma_f32_16x16x32_bf16 v[48:51], v[24:27], v[208:211], v[48:51]
  ds_read_b64_tr_b16 v[220:221], v7 offset:57344
  v_mfma_f32_16x16x32_bf16 v[52:55], v[24:27], v[212:215], v[52:55]
  ds_read_b64_tr_b16 v[222:223], v7 offset:58368
  ds_read_b128 v[32:35], v23 offset:8192
  s_waitcnt lgkmcnt(5)
  v_mfma_f32_16x16x32_bf16 v[56:59], v[28:31], v[200:203], v[56:59]
  ds_read_b64_tr_b16 v[224:225], v8 offset:57344
  v_mfma_f32_16x16x32_bf16 v[60:63], v[28:31], v[204:207], v[60:63]
  ds_read_b64_tr_b16 v[226:227], v8 offset:58368
  v_mfma_f32_16x16x32_bf16 v[64:67], v[28:31], v[208:211], v[64:67]
  ds_read_b64_tr_b16 v[228:229], v9 offset:57344
  v_mfma_f32_16x16x32_bf16 v[68:71], v[28:31], v[212:215], v[68:71]
  ds_read_b64_tr_b16 v[230:231], v9 offset:58368
  ds_read_b128 v[36:39], v23 offset:12288
  s_waitcnt vmcnt(0) lgkmcnt(0)
  s_barrier
  v_add_u32 v20, s57, v10
  v_xor_b32 v21, 64, v20
  v_xor_b32 v22, 128, v20
  v_xor_b32 v23, 192, v20
  ds_read_b128 v[24:27], v20 offset:0
  ds_read_b128 v[28:31], v21 offset:0
  v_mfma_f32_16x16x32_bf16 v[40:43], v[32:35], v[216:219], v[40:43]
  v_mfma_f32_16x16x32_bf16 v[44:47], v[32:35], v[220:223], v[44:47]
  v_mfma_f32_16x16x32_bf16 v[48:51], v[32:35], v[224:227], v[48:51]
  v_mfma_f32_16x16x32_bf16 v[52:55], v[32:35], v[228:231], v[52:55]
  ds_read_b128 v[32:35], v22 offset:0
  s_cbranch_vccnz k1_skip11
  s_add_u32 m0, s52, 32768
  s_nop 0
  buffer_load_dwordx4 v4, s[28:31], s53 offen lds
  s_add_u32 m0, s52, 40960
  s_nop 0
  buffer_load_dwordx4 v5, s[28:31], s53 offen lds
  s_add_u32 s53, s53, 16384
k1_skip11:
  v_mfma_f32_16x16x32_bf16 v[56:59], v[36:39], v[216:219], v[56:59]
  v_mfma_f32_16x16x32_bf16 v[60:63], v[36:39], v[220:223], v[60:63]
  v_mfma_f32_16x16x32_bf16 v[64:67], v[36:39], v[224:227], v[64:67]
  v_mfma_f32_16x16x32_bf16 v[68:71], v[36:39], v[228:231], v[68:71]
  ds_read_b128 v[36:39], v23 offset:0
  s_cbranch_vccz k1_skip12
  s_add_u32 m0, s52, 32768
  s_nop 0
  buffer_load_dwordx4 v4, s[28:31], s53 offen lds
  s_add_u32 m0, s52, 40960
  s_nop 0
  buffer_load_dwordx4 v5, s[28:31], s53 offen lds
  s_add_u32 s53, s53, 16384
k1_skip12:
  s_waitcnt lgkmcnt(3)
  v_mfma_f32_16x16x32_bf16 v[72:75], v[24:27], v[104:107], 0
  v_mfma_f32_16x16x32_bf16 v[76:79], v[24:27], v[108:111], 0
  v_mfma_f32_16x16x32_bf16 v[80:83], v[24:27], v[112:115], 0
  v_mfma_f32_16x16x32_bf16 v[84:87], v[24:27], v[116:119], 0
  ds_read_b128 v[24:27], v20 offset:8192
  s_cbranch_vccnz k1_skip13
  s_add_u32 m0, s52, 49152
  s_nop 0
  buffer_load_dwordx4 v4, s[28:31], s53 offen lds
  s_add_u32 m0, s52, 57344
  s_nop 0
  buffer_load_dwordx4 v5, s[28:31], s53 offen lds
  s_add_u32 s53, s53, 16384
k1_skip13:
  s_waitcnt lgkmcnt(3)
  v_mfma_f32_16x16x32_bf16 v[72:75], v[28:31], v[120:123], v[72:75]
  v_mfma_f32_16x16x32_bf16 v[76:79], v[28:31], v[124:127], v[76:79]
  v_mfma_f32_16x16x32_bf16 v[80:83], v[28:31], v[128:131], v[80:83]
  v_mfma_f32_16x16x32_bf16 v[84:87], v[28:31], v[132:135], v[84:87]
  ds_read_b128 v[28:31], v21 offset:8192
  s_cbranch_vccz k1_skip14
  s_add_u32 m0, s52, 49152
  s_nop 0
  buffer_load_dwordx4 v4, s[28:31], s53 offen lds
  s_add_u32 m0, s52, 57344
  s_nop 0
  buffer_load_dwordx4 v5, s[28:31], s53 offen lds
  s_add_u32 s53, s53, 16384
k1_skip14:
  s_waitcnt lgkmcnt(3)
  v_mfma_f32_16x16x32_bf16 v[72:75], v[32:35], v[136:139], v[72:75]
  v_mfma_f32_16x16x32_bf16 v[76:79], v[32:35], v[140:143], v[76:79]
  v_mfma_f32_16x16x32_bf16 v[80:83], v[32:35], v[144:147], v[80:83]
  v_mfma_f32_16x16x32_bf16 v[84:87], v[32:35], v[148:151], v[84:87]
  ds_read_b128 v[32:35], v22 offset:8192
  s_cbranch_vccnz k1_skip15
  s_add_u32 m0, s52, 65536
  s_nop 0
  buffer_load_dwordx4 v4, s[28:31], s53 offen lds
  s_add_u32 m0, s52, 73728
  s_nop 0
  buffer_load_dwordx4 v5, s[28:31], s53 offen lds
  s_add_u32 s53, s53, 16384
k1_skip15:
  s_waitcnt lgkmcnt(3)
  v_mfma_f32_16x16x32_bf16 v[72:75], v[36:39], v[152:155], v[72:75]
  v_mfma_f32_16x16x32_bf16 v[76:79], v[36:39], v[156:159], v[76:79]
  v_mfma_f32_16x16x32_bf16 v[80:83], v[36:39], v[160:163], v[80:83]
  v_mfma_f32_16x16x32_bf16 v[84:87], v[36:39], v[164:167], v[84:87]
  ds_read_b128 v[36:39], v23 offset:8192
  s_cbranch_vccz k1_skip16
  s_add_u32 m0, s52, 65536
  s_nop 0
  buffer_load_dwordx4 v4, s[28:31], s53 offen lds
  s_add_u32 m0, s52, 73728
  s_nop 0
  buffer_load_dwordx4 v5, s[28:31], s53 offen lds
  s_add_u32 s53, s53, 16384
k1_skip16:
  s_waitcnt lgkmcnt(3)
  v_mfma_f32_16x16x32_bf16 v[72:75], v[24:27], v[168:171], v[72:75]
  v_fma_f32 v40, v40, s50, v12
  v_fma_f32 v44, v44, s50, v13
  v_mfma_f32_16x16x32_bf16 v[76:79], v[24:27], v[172:175], v[76:79]
  v_fma_f32 v48, v48, s50, v14
  v_fma_f32 v52, v52, s50, v15
  v_mfma_f32_16x16x32_bf16 v[80:83], v[24:27], v[176:179], v[80:83]
  v_fma_f32 v41, v41, s50, v12
  v_fma_f32 v45, v45, s50, v13
  v_mfma_f32_16x16x32_bf16 v[84:87], v[24:27], v[180:183], v[84:87]
  v_fma_f32 v49, v49, s50, v14
  v_fma_f32 v53, v53, s50, v15
  ds_read_b128 v[24:27], v20 offset:4096
  s_cbranch_vccnz k1_skip17
  s_add_u32 m0, s52, 81920
  s_nop 0
  buffer_load_dwordx4 v4, s[28:31], s53 offen lds
  s_add_u32 m0, s52, 90112
  s_nop 0
  buffer_load_dwordx4 v5, s[28:31], s53 offen lds
  s_add_u32 s53, s53, 16384
k1_skip17:
  s_waitcnt lgkmcnt(3)
  v_mfma_f32_16x16x32_bf16 v[72:75], v[28:31], v[184:187], v[72:75]
  v_cvt_pk_bf16_f32 v40, v40, v44
  v_cvt_pk_bf16_f32 v44, v41, v45
  v_mfma_f32_16x16x32_bf16 v[76:79], v[28:31], v[188:191], v[76:79]
  v_cvt_pk_bf16_f32 v41, v48, v52
  v_cvt_pk_bf16_f32 v45, v49, v53
  v_mfma_f32_16x16x32_bf16 v[80:83], v[28:31], v[192:195], v[80:83]
  buffer_store_dwordx2 v[40:41], v11, s[36:39], s59 offen offset:0 sc1
  buffer_store_dwordx2 v[44:45], v11, s[36:39], s59 offen offset:128 sc1
  v_mfma_f32_16x16x32_bf16 v[84:87], v[28:31], v[196:199], v[84:87]
  v_fma_f32 v42, v42, s50, v12
  v_fma_f32 v46, v46, s50, v13
  ds_read_b128 v[28:31], v21 offset:4096
  s_cbranch_vccz k1_skip18
  s_add_u32 m0, s52, 81920
  s_nop 0
  buffer_load_dwordx4 v4, s[28:31], s53 offen lds
  s_add_u32 m0, s52, 90112
  s_nop 0
  buffer_load_dwordx4 v5, s[28:31], s53 offen lds
  s_add_u32 s53, s53, 16384
k1_skip18:
  s_waitcnt lgkmcnt(3)
  v_mfma_f32_16x16x32_bf16 v[72:75], v[32:35], v[200:203], v[72:75]
  v_fma_f32 v50, v50, s50, v14
  v_fma_f32 v54, v54, s50, v15
  v_mfma_f32_16x16x32_bf16 v[76:79], v[32:35], v[204:207], v[76:79]
  v_fma_f32 v43, v43, s50, v12
  v_fma_f32 v47, v47, s50, v13
  v_mfma_f32_16x16x32_bf16 v[80:83], v[32:35], v[208:211], v[80:83]
  v_fma_f32 v51, v51, s50, v14
  v_fma_f32 v55, v55, s50, v15
  v_mfma_f32_16x16x32_bf16 v[84:87], v[32:35], v[212:215], v[84:87]
  v_cvt_pk_bf16_f32 v42, v42, v46
  v_cvt_pk_bf16_f32 v46, v43, v47
  ds_read_b128 v[32:35], v22 offset:4096
  s_waitcnt lgkmcnt(3)
  v_mfma_f32_16x16x32_bf16 v[72:75], v[36:39], v[216:219], v[72:75]
  v_cvt_pk_bf16_f32 v43, v50, v54
  v_cvt_pk_bf16_f32 v47, v51, v55
  v_mfma_f32_16x16x32_bf16 v[76:79], v[36:39], v[220:223], v[76:79]
  buffer_store_dwordx2 v[42:43], v11, s[36:39], s59 offen offset:256 sc1
  buffer_store_dwordx2 v[46:47], v11, s[36:39], s59 offen offset:384 sc1
  v_mfma_f32_16x16x32_bf16 v[80:83], v[36:39], v[224:227], v[80:83]
  v_fma_f32 v56, v56, s50, v12
  v_fma_f32 v60, v60, s50, v13
  v_mfma_f32_16x16x32_bf16 v[84:87], v[36:39], v[228:231], v[84:87]
  v_fma_f32 v64, v64, s50, v14
  v_fma_f32 v68, v68, s50, v15
  ds_read_b128 v[36:39], v23 offset:4096
  s_waitcnt lgkmcnt(3)
  v_mfma_f32_16x16x32_bf16 v[88:91], v[24:27], v[104:107], 0
  v_fma_f32 v57, v57, s50, v12
  v_fma_f32 v61, v61, s50, v13
  v_mfma_f32_16x16x32_bf16 v[92:95], v[24:27], v[108:111], 0
  v_fma_f32 v65, v65, s50, v14
  v_fma_f32 v69, v69, s50, v15
  v_mfma_f32_16x16x32_bf16 v[96:99], v[24:27], v[112:115], 0
  v_cvt_pk_bf16_f32 v56, v56, v60
  v_cvt_pk_bf16_f32 v60, v57, v61
  v_mfma_f32_16x16x32_bf16 v[100:103], v[24:27], v[116:119], 0
  v_cvt_pk_bf16_f32 v57, v64, v68
  v_cvt_pk_bf16_f32 v61, v65, v69
  ds_read_b128 v[24:27], v20 offset:12288
  s_waitcnt lgkmcnt(3)
  v_mfma_f32_16x16x32_bf16 v[88:91], v[28:31], v[120:123], v[88:91]
  buffer_store_dwordx2 v[56:57], v11, s[36:39], s59 offen offset:2048 sc1
  buffer_store_dwordx2 v[60:61], v11, s[36:39], s59 offen offset:2176 sc1
  v_mfma_f32_16x16x32_bf16 v[92:95], v[28:31], v[124:127], v[92:95]
  v_fma_f32 v58, v58, s50, v12
  v_fma_f32 v62, v62, s50, v13
  v_mfma_f32_16x16x32_bf16 v[96:99], v[28:31], v[128:131], v[96:99]
  v_fma_f32 v66, v66, s50, v14
  v_fma_f32 v70, v70, s50, v15
  v_mfma_f32_16x16x32_bf16 v[100:103], v[28:31], v[132:135], v[100:103]
  v_fma_f32 v59, v59, s50, v12
  v_fma_f32 v63, v63, s50, v13
  ds_read_b128 v[28:31], v21 offset:12288
  s_waitcnt lgkmcnt(3)
  v_mfma_f32_16x16x32_bf16 v[88:91], v[32:35], v[136:139], v[88:91]
  v_fma_f32 v67, v67, s50, v14
  v_fma_f32 v71, v71, s50, v15
  v_mfma_f32_16x16x32_bf16 v[92:95], v[32:35], v[140:143], v[92:95]
  v_cvt_pk_bf16_f32 v58, v58, v62
  v_cvt_pk_bf16_f32 v62, v59, v63
  v_mfma_f32_16x16x32_bf16 v[96:99], v[32:35], v[144:147], v[96:99]
  v_cvt_pk_bf16_f32 v59, v66, v70
  v_cvt_pk_bf16_f32 v63, v67, v71
  v_mfma_f32_16x16x32_bf16 v[100:103], v[32:35], v[148:151], v[100:103]
  buffer_store_dwordx2 v[58:59], v11, s[36:39], s59 offen offset:2304 sc1
  buffer_store_dwordx2 v[62:63], v11, s[36:39], s59 offen offset:2432 sc1
  ds_read_b128 v[32:35], v22 offset:12288
  s_waitcnt lgkmcnt(3)
  v_mfma_f32_16x16x32_bf16 v[88:91], v[36:39], v[152:155], v[88:91]
  v_fma_f32 v72, v72, s50, v12
  v_fma_f32 v76, v76, s50, v13
  v_mfma_f32_16x16x32_bf16 v[92:95], v[36:39], v[156:159], v[92:95]
  v_fma_f32 v80, v80, s50, v14
  v_fma_f32 v84, v84, s50, v15
  v_mfma_f32_16x16x32_bf16 v[96:99], v[36:39], v[160:163], v[96:99]
  v_fma_f32 v73, v73, s50, v12
  v_fma_f32 v77, v77, s50, v13
  v_mfma_f32_16x16x32_bf16 v[100:103], v[36:39], v[164:167], v[100:103]
  v_fma_f32 v81, v81, s50, v14
  v_fma_f32 v85, v85, s50, v15
  ds_read_b128 v[36:39], v23 offset:12288
  s_waitcnt vmcnt(6) lgkmcnt(0)
  s_barrier
  v_add_u32 v20, s58, v10
  v_xor_b32 v21, 64, v20
  v_xor_b32 v22, 128, v20
  v_xor_b32 v23, 192, v20
  v_mfma_f32_16x16x32_bf16 v[88:91], v[24:27], v[168:171], v[88:91]
  v_cvt_pk_bf16_f32 v72, v72, v76
  v_cvt_pk_bf16_f32 v76, v73, v77
  v_mfma_f32_16x16x32_bf16 v[92:95], v[24:27], v[172:175], v[92:95]
  v_cvt_pk_bf16_f32 v73, v80, v84
  v_cvt_pk_bf16_f32 v77, v81, v85
  v_mfma_f32_16x16x32_bf16 v[96:99], v[24:27], v[176:179], v[96:99]
  buffer_store_dwordx2 v[72:73], v11, s[36:39], s60 offen offset:0 sc1
  buffer_store_dwordx2 v[76:77], v11, s[36:39], s60 offen offset:128 sc1
  v_mfma_f32_16x16x32_bf16 v[100:103], v[24:27], v[180:183], v[100:103]
  v_fma_f32 v74, v74, s50, v12
  v_fma_f32 v78, v78, s50, v13
  ds_read_b128 v[24:27], v20 offset:0
  v_mfma_f32_16x16x32_bf16 v[88:91], v[28:31], v[184:187], v[88:91]
  v_fma_f32 v82, v82, s50, v14
  v_fma_f32 v86, v86, s50, v15
  v_mfma_f32_16x16x32_bf16 v[92:95], v[28:31], v[188:191], v[92:95]
  v_fma_f32 v75, v75, s50, v12
  v_fma_f32 v79, v79, s50, v13
  v_mfma_f32_16x16x32_bf16 v[96:99], v[28:31], v[192:195], v[96:99]
  v_fma_f32 v83, v83, s50, v14
  v_fma_f32 v87, v87, s50, v15
  v_mfma_f32_16x16x32_bf16 v[100:103], v[28:31], v[196:199], v[100:103]
  v_cvt_pk_bf16_f32 v74, v74, v78
  v_cvt_pk_bf16_f32 v78, v75, v79
  ds_read_b128 v[28:31], v21 offset:0
  v_mfma_f32_16x16x32_bf16 v[88:91], v[32:35], v[200:203], v[88:91]
  v_cvt_pk_bf16_f32 v75, v82, v86
  v_cvt_pk_bf16_f32 v79, v83, v87
  v_mfma_f32_16x16x32_bf16 v[92:95], v[32:35], v[204:207], v[92:95]
  buffer_store_dwordx2 v[74:75], v11, s[36:39], s60 offen offset:256 sc1
  buffer_store_dwordx2 v[78:79], v11, s[36:39], s60 offen offset:384 sc1
  v_mfma_f32_16x16x32_bf16 v[96:99], v[32:35], v[208:211], v[96:99]
  v_mfma_f32_16x16x32_bf16 v[100:103], v[32:35], v[212:215], v[100:103]
  ds_read_b128 v[32:35], v22 offset:0
  v_mfma_f32_16x16x32_bf16 v[88:91], v[36:39], v[216:219], v[88:91]
  v_mfma_f32_16x16x32_bf16 v[92:95], v[36:39], v[220:223], v[92:95]
  v_mfma_f32_16x16x32_bf16 v[96:99], v[36:39], v[224:227], v[96:99]
  v_mfma_f32_16x16x32_bf16 v[100:103], v[36:39], v[228:231], v[100:103]
  ds_read_b128 v[36:39], v23 offset:0
  s_add_u32 s54, s48, 8
  s_cmp_ge_u32 s54, s45
  s_cbranch_scc1 k1_gemm_short
  s_waitcnt lgkmcnt(3)
  v_mfma_f32_16x16x32_bf16 v[40:43], v[24:27], v[104:107], 0
  v_mfma_f32_16x16x32_bf16 v[44:47], v[24:27], v[108:111], 0
  v_mfma_f32_16x16x32_bf16 v[48:51], v[24:27], v[112:115], 0
  v_mfma_f32_16x16x32_bf16 v[52:55], v[24:27], v[116:119], 0
  ds_read_b128 v[24:27], v20 offset:8192
  s_waitcnt lgkmcnt(3)
  v_mfma_f32_16x16x32_bf16 v[40:43], v[28:31], v[120:123], v[40:43]
  v_mfma_f32_16x16x32_bf16 v[44:47], v[28:31], v[124:127], v[44:47]
  v_mfma_f32_16x16x32_bf16 v[48:51], v[28:31], v[128:131], v[48:51]
  v_mfma_f32_16x16x32_bf16 v[52:55], v[28:31], v[132:135], v[52:55]
  ds_read_b128 v[28:31], v21 offset:8192
  s_waitcnt lgkmcnt(3)
  v_mfma_f32_16x16x32_bf16 v[40:43], v[32:35], v[136:139], v[40:43]
  v_fma_f32 v88, v88, s50, v12
  v_fma_f32 v92, v92, s50, v13
  v_mfma_f32_16x16x32_bf16 v[44:47], v[32:35], v[140:143], v[44:47]
  v_fma_f32 v96, v96, s50, v14
  v_fma_f32 v100, v100, s50, v15
  v_mfma_f32_16x16x32_bf16 v[48:51], v[32:35], v[144:147], v[48:51]
  v_fma_f32 v89, v89, s50, v12
  v_fma_f32 v93, v93, s50, v13
  v_mfma_f32_16x16x32_bf16 v[52:55], v[32:35], v[148:151], v[52:55]
  v_fma_f32 v97, v97, s50, v14
  v_fma_f32 v101, v101, s50, v15
  ds_read_b128 v[32:35], v22 offset:8192
  s_waitcnt lgkmcnt(3)
  v_mfma_f32_16x16x32_bf16 v[40:43], v[36:39], v[152:155], v[40:43]
  v_cvt_pk_bf16_f32 v88, v88, v92
  v_cvt_pk_bf16_f32 v92, v89, v93
  v_mfma_f32_16x16x32_bf16 v[44:47], v[36:39], v[156:159], v[44:47]
  v_cvt_pk_bf16_f32 v89, v96, v100
  v_cvt_pk_bf16_f32 v93, v97, v101
  v_mfma_f32_16x16x32_bf16 v[48:51], v[36:39], v[160:163], v[48:51]
  buffer_store_dwordx2 v[88:89], v11, s[36:39], s60 offen offset:2048 sc1
  buffer_store_dwordx2 v[92:93], v11, s[36:39], s60 offen offset:2176 sc1
  v_mfma_f32_16x16x32_bf16 v[52:55], v[36:39], v[164:167], v[52:55]
  v_fma_f32 v90, v90, s50, v12
  v_fma_f32 v94, v94, s50, v13
  ds_read_b128 v[36:39], v23 offset:8192
  s_waitcnt lgkmcnt(3)
  v_mfma_f32_16x16x32_bf16 v[40:43], v[24:27], v[168:171], v[40:43]
  v_fma_f32 v98, v98, s50, v14
  v_fma_f32 v102, v102, s50, v15
  v_mfma_f32_16x16x32_bf16 v[44:47], v[24:27], v[172:175], v[44:47]
  v_fma_f32 v91, v91, s50, v12
  v_fma_f32 v95, v95, s50, v13
  v_mfma_f32_16x16x32_bf16 v[48:51], v[24:27], v[176:179], v[48:51]
  v_fma_f32 v99, v99, s50, v14
  v_fma_f32 v103, v103, s50, v15
  v_mfma_f32_16x16x32_bf16 v[52:55], v[24:27], v[180:183], v[52:55]
  v_cvt_pk_bf16_f32 v90, v90, v94
  v_cvt_pk_bf16_f32 v94, v91, v95
  ds_read_b128 v[24:27], v20 offset:4096
  s_waitcnt lgkmcnt(3)
  v_mfma_f32_16x16x32_bf16 v[40:43], v[28:31], v[184:187], v[40:43]
  v_cvt_pk_bf16_f32 v91, v98, v102
  v_cvt_pk_bf16_f32 v95, v99, v103
  v_mfma_f32_16x16x32_bf16 v[44:47], v[28:31], v[188:191], v[44:47]
  buffer_store_dwordx2 v[90:91], v11, s[36:39], s60 offen offset:2304 sc1
  buffer_store_dwordx2 v[94:95], v11, s[36:39], s60 offen offset:2432 sc1
  v_mfma_f32_16x16x32_bf16 v[48:51], v[28:31], v[192:195], v[48:51]
  v_mfma_f32_16x16x32_bf16 v[52:55], v[28:31], v[196:199], v[52:55]
  ds_read_b128 v[28:31], v21 offset:4096
  s_waitcnt lgkmcnt(3)
  v_mfma_f32_16x16x32_bf16 v[40:43], v[32:35], v[200:203], v[40:43]
  v_mfma_f32_16x16x32_bf16 v[44:47], v[32:35], v[204:207], v[44:47]
  v_mfma_f32_16x16x32_bf16 v[48:51], v[32:35], v[208:211], v[48:51]
  v_mfma_f32_16x16x32_bf16 v[52:55], v[32:35], v[212:215], v[52:55]
  ds_read_b128 v[32:35], v22 offset:4096
  s_waitcnt lgkmcnt(3)
  v_mfma_f32_16x16x32_bf16 v[40:43], v[36:39], v[216:219], v[40:43]
  v_mfma_f32_16x16x32_bf16 v[44:47], v[36:39], v[220:223], v[44:47]
  v_mfma_f32_16x16x32_bf16 v[48:51], v[36:39], v[224:227], v[48:51]
  v_mfma_f32_16x16x32_bf16 v[52:55], v[36:39], v[228:231], v[52:55]
  ds_read_b128 v[36:39], v23 offset:4096
  s_waitcnt lgkmcnt(3)
  v_mfma_f32_16x16x32_bf16 v[56:59], v[24:27], v[104:107], 0
  v_mfma_f32_16x16x32_bf16 v[60:63], v[24:27], v[108:111], 0
  v_mfma_f32_16x16x32_bf16 v[64:67], v[24:27], v[112:115], 0
  v_mfma_f32_16x16x32_bf16 v[68:71], v[24:27], v[116:119], 0
  ds_read_b128 v[24:27], v20 offset:12288
  s_waitcnt lgkmcnt(3)
  v_mfma_f32_16x16x32_bf16 v[56:59], v[28:31], v[120:123], v[56:59]
  v_mfma_f32_16x16x32_bf16 v[60:63], v[28:31], v[124:127], v[60:63]
  v_mfma_f32_16x16x32_bf16 v[64:67], v[28:31], v[128:131], v[64:67]
  v_mfma_f32_16x16x32_bf16 v[68:71], v[28:31], v[132:135], v[68:71]
  ds_read_b128 v[28:31], v21 offset:12288
  s_waitcnt lgkmcnt(3)
  v_mfma_f32_16x16x32_bf16 v[56:59], v[32:35], v[136:139], v[56:59]
  v_fma_f32 v40, v40, s50, v12
  v_fma_f32 v44, v44, s50, v13
  v_mfma_f32_16x16x32_bf16 v[60:63], v[32:35], v[140:143], v[60:63]
  v_fma_f32 v48, v48, s50, v14
  v_fma_f32 v52, v52, s50, v15
  v_mfma_f32_16x16x32_bf16 v[64:67], v[32:35], v[144:147], v[64:67]
  v_fma_f32 v41, v41, s50, v12
  v_fma_f32 v45, v45, s50, v13
  v_mfma_f32_16x16x32_bf16 v[68:71], v[32:35], v[148:151], v[68:71]
  v_fma_f32 v49, v49, s50, v14
  v_fma_f32 v53, v53, s50, v15
  ds_read_b128 v[32:35], v22 offset:12288
  s_waitcnt lgkmcnt(3)
  v_mfma_f32_16x16x32_bf16 v[56:59], v[36:39], v[152:155], v[56:59]
  v_cvt_pk_bf16_f32 v40, v40, v44
  v_cvt_pk_bf16_f32 v44, v41, v45
  v_mfma_f32_16x16x32_bf16 v[60:63], v[36:39], v[156:159], v[60:63]
  v_cvt_pk_bf16_f32 v41, v48, v52
  v_cvt_pk_bf16_f32 v45, v49, v53
  v_mfma_f32_16x16x32_bf16 v[64:67], v[36:39], v[160:163], v[64:67]
  buffer_store_dwordx2 v[40:41], v11, s[36:39], s61 offen offset:0 sc1
  buffer_store_dwordx2 v[44:45], v11, s[36:39], s61 offen offset:128 sc1
  v_mfma_f32_16x16x32_bf16 v[68:71], v[36:39], v[164:167], v[68:71]
  v_fma_f32 v42, v42, s50, v12
  v_fma_f32 v46, v46, s50, v13
  ds_read_b128 v[36:39], v23 offset:12288
  s_waitcnt lgkmcnt(3)
  v_mfma_f32_16x16x32_bf16 v[56:59], v[24:27], v[168:171], v[56:59]
  v_fma_f32 v50, v50, s50, v14
  v_fma_f32 v54, v54, s50, v15
  v_mfma_f32_16x16x32_bf16 v[60:63], v[24:27], v[172:175], v[60:63]
  v_fma_f32 v43, v43, s50, v12
  v_fma_f32 v47, v47, s50, v13
  v_mfma_f32_16x16x32_bf16 v[64:67], v[24:27], v[176:179], v[64:67]
  v_fma_f32 v51, v51, s50, v14
  v_fma_f32 v55, v55, s50, v15
  v_mfma_f32_16x16x32_bf16 v[68:71], v[24:27], v[180:183], v[68:71]
  v_cvt_pk_bf16_f32 v42, v42, v46
  v_cvt_pk_bf16_f32 v46, v43, v47
  s_waitcnt lgkmcnt(2)
  v_mfma_f32_16x16x32_bf16 v[56:59], v[28:31], v[184:187], v[56:59]
  v_cvt_pk_bf16_f32 v43, v50, v54
  v_cvt_pk_bf16_f32 v47, v51, v55
  v_mfma_f32_16x16x32_bf16 v[60:63], v[28:31], v[188:191], v[60:63]
  buffer_store_dwordx2 v[42:43], v11, s[36:39], s61 offen offset:256 sc1
  buffer_store_dwordx2 v[46:47], v11, s[36:39], s61 offen offset:384 sc1
  v_mfma_f32_16x16x32_bf16 v[64:67], v[28:31], v[192:195], v[64:67]
  v_mfma_f32_16x16x32_bf16 v[68:71], v[28:31], v[196:199], v[68:71]
  s_waitcnt lgkmcnt(1)
  v_mfma_f32_16x16x32_bf16 v[56:59], v[32:35], v[200:203], v[56:59]
  v_mfma_f32_16x16x32_bf16 v[60:63], v[32:35], v[204:207], v[60:63]
  v_mfma_f32_16x16x32_bf16 v[64:67], v[32:35], v[208:211], v[64:67]
  v_mfma_f32_16x16x32_bf16 v[68:71], v[32:35], v[212:215], v[68:71]
  s_waitcnt lgkmcnt(0)
  v_mfma_f32_16x16x32_bf16 v[56:59], v[36:39], v[216:219], v[56:59]
  v_mfma_f32_16x16x32_bf16 v[60:63], v[36:39], v[220:223], v[60:63]
  v_mfma_f32_16x16x32_bf16 v[64:67], v[36:39], v[224:227], v[64:67]
  v_mfma_f32_16x16x32_bf16 v[68:71], v[36:39], v[228:231], v[68:71]
  s_nop 7
  v_fma_f32 v56, v56, s50, v12
  v_fma_f32 v60, v60, s50, v13
  v_fma_f32 v64, v64, s50, v14
  v_fma_f32 v68, v68, s50, v15
  v_fma_f32 v57, v57, s50, v12
  v_fma_f32 v61, v61, s50, v13
  v_fma_f32 v65, v65, s50, v14
  v_fma_f32 v69, v69, s50, v15
  v_cvt_pk_bf16_f32 v56, v56, v60
  v_cvt_pk_bf16_f32 v60, v57, v61
  v_cvt_pk_bf16_f32 v57, v64, v68
  v_cvt_pk_bf16_f32 v61, v65, v69
  buffer_store_dwordx2 v[56:57], v11, s[36:39], s61 offen offset:2048 sc1
  buffer_store_dwordx2 v[60:61], v11, s[36:39], s61 offen offset:2176 sc1
  v_fma_f32 v58, v58, s50, v12
  v_fma_f32 v62, v62, s50, v13
  v_fma_f32 v66, v66, s50, v14
  v_fma_f32 v70, v70, s50, v15
  v_fma_f32 v59, v59, s50, v12
  v_fma_f32 v63, v63, s50, v13
  v_fma_f32 v67, v67, s50, v14
  v_fma_f32 v71, v71, s50, v15
  v_cvt_pk_bf16_f32 v58, v58, v62
  v_cvt_pk_bf16_f32 v62, v59, v63
  v_cvt_pk_bf16_f32 v59, v66, v70
  v_cvt_pk_bf16_f32 v63, v67, v71
  buffer_store_dwordx2 v[58:59], v11, s[36:39], s61 offen offset:2304 sc1
  buffer_store_dwordx2 v[62:63], v11, s[36:39], s61 offen offset:2432 sc1
k1_gemm_end:
  s_endpgm
k1_gemm_short:
  s_nop 7
  v_fma_f32 v88, v88, s50, v12
  v_fma_f32 v92, v92, s50, v13
  v_fma_f32 v96, v96, s50, v14
  v_fma_f32 v100, v100, s50, v15
  v_fma_f32 v89, v89, s50, v12
  v_fma_f32 v93, v93, s50, v13
  v_fma_f32 v97, v97, s50, v14
  v_fma_f32 v101, v101, s50, v15
  v_cvt_pk_bf16_f32 v88, v88, v92
  v_cvt_pk_bf16_f32 v92, v89, v93
  v_cvt_pk_bf16_f32 v89, v96, v100
  v_cvt_pk_bf16_f32 v93, v97, v101
  buffer_store_dwordx2 v[88:89], v11, s[36:39], s60 offen offset:2048 sc1
  buffer_store_dwordx2 v[92:93], v11, s[36:39], s60 offen offset:2176 sc1
  v_fma_f32 v90, v90, s50, v12
  v_fma_f32 v94, v94, s50, v13
  v_fma_f32 v98, v98, s50, v14
  v_fma_f32 v102, v102, s50, v15
  v_fma_f32 v91, v91, s50, v12
  v_fma_f32 v95, v95, s50, v13
  v_fma_f32 v99, v99, s50, v14
  v_fma_f32 v103, v103, s50, v15
  v_cvt_pk_bf16_f32 v90, v90, v94
  v_cvt_pk_bf16_f32 v94, v91, v95
  v_cvt_pk_bf16_f32 v91, v98, v102
  v_cvt_pk_bf16_f32 v95, v99, v103
  buffer_store_dwordx2 v[90:91], v11, s[36:39], s60 offen offset:2304 sc1
  buffer_store_dwordx2 v[94:95], v11, s[36:39], s60 offen offset:2432 sc1
  s_branch k1_gemm_end
k1_prep:
  v_lshrrev_b32 v3, 4, v1
  v_and_b32 v4, 15, v1
  v_lshlrev_b32 v4, 2, v4
  v_lshl_add_u32 v2, v3, 10, v4
  v_lshlrev_b32 v6, 4, v1
  s_mov_b32 s42, 0x05040100
  s_mov_b32 s43, 0x07060302
  s_waitcnt lgkmcnt(0)
  s_mov_b32 s28, s16
  s_mov_b32 s29, s17
  s_mov_b32 s30, 262144
  s_mov_b32 s31, 0x00020000
  s_mov_b32 s32, s24
  s_mov_b32 s33, s25
  s_mov_b32 s34, 24973312
  s_mov_b32 s35, 0x00020000
  s_mov_b32 s36, s12
  s_mov_b32 s37, s13
  s_mov_b32 s38, 525312
  s_mov_b32 s39, 0x00020000
  s_lshl_b32 s40, s26, 15
  s_lshl_b32 s41, s27, 6
  s_add_u32 s40, s40, s41
  s_add_u32 s41, s40, 0
  buffer_load_dword v8, v2, s[28:31], s41 offen offset:0
  s_add_u32 s41, s40, 8192
  buffer_load_dword v9, v2, s[28:31], s41 offen offset:0
  s_add_u32 s41, s40, 16384
  buffer_load_dword v10, v2, s[28:31], s41 offen offset:0
  s_add_u32 s41, s40, 24576
  buffer_load_dword v11, v2, s[28:31], s41 offen offset:0
  s_add_u32 s41, s40, 0
  buffer_load_dword v12, v2, s[28:31], s41 offen offset:512
  s_add_u32 s41, s40, 8192
  buffer_load_dword v13, v2, s[28:31], s41 offen offset:512
  s_add_u32 s41, s40, 16384
  buffer_load_dword v14, v2, s[28:31], s41 offen offset:512
  s_add_u32 s41, s40, 24576
  buffer_load_dword v15, v2, s[28:31], s41 offen offset:512
  s_add_u32 s41, s40, 4096
  buffer_load_dword v16, v2, s[28:31], s41 offen offset:0
  s_add_u32 s41, s40, 12288
  buffer_load_dword v17, v2, s[28:31], s41 offen offset:0
  s_add_u32 s41, s40, 20480
  buffer_load_dword v18, v2, s[28:31], s41 offen offset:0
  s_add_u32 s41, s40, 28672
  buffer_load_dword v19, v2, s[28:31], s41 offen offset:0
  s_add_u32 s41, s40, 4096
  buffer_load_dword v20, v2, s[28:31], s41 offen offset:512
  s_add_u32 s41, s40, 12288
  buffer_load_dword v21, v2, s[28:31], s41 offen offset:512
  s_add_u32 s41, s40, 20480
  buffer_load_dword v22, v2, s[28:31], s41 offen offset:512
  s_add_u32 s41, s40, 28672
  buffer_load_dword v23, v2, s[28:31], s41 offen offset:512
  s_lshl_b32 s40, s27, 15
  s_lshl_b32 s41, s26, 12
  s_add_u32 s40, s40, s41
  s_add_u32 s40, s40, 20971520
  s_waitcnt vmcnt(8)
  v_perm_b32 v24, v9, v8, s42
  v_perm_b32 v25, v11, v10, s42
  v_perm_b32 v26, v13, v12, s42
  v_perm_b32 v27, v15, v14, s42
  buffer_store_dwordx4 v[24:27], v6, s[32:35], s40 offen offset:0 sc1
  v_perm_b32 v28, v9, v8, s43
  v_perm_b32 v29, v11, v10, s43
  v_perm_b32 v30, v13, v12, s43
  v_perm_b32 v31, v15, v14, s43
  buffer_store_dwordx4 v[28:31], v6, s[32:35], s40 offen offset:1024 sc1
  s_waitcnt vmcnt(2)
  v_perm_b32 v32, v17, v16, s42
  v_perm_b32 v33, v19, v18, s42
  v_perm_b32 v34, v21, v20, s42
  v_perm_b32 v35, v23, v22, s42
  buffer_store_dwordx4 v[32:35], v6, s[32:35], s40 offen offset:2048 sc1
  v_perm_b32 v36, v17, v16, s43
  v_perm_b32 v37, v19, v18, s43
  v_perm_b32 v38, v21, v20, s43
  v_perm_b32 v39, v23, v22, s43
  buffer_store_dwordx4 v[36:39], v6, s[32:35], s40 offen offset:3072 sc1
  s_cmp_eq_u32 s26, 1
  s_cbranch_scc1 k1_prep_zero
  s_cmp_lg_u32 s26, 0
  s_cbranch_scc1 k1_exit
  v_and_b32 v3, 3, v1
  v_lshlrev_b32 v3, 4, v3
  v_bfe_u32 v4, v1, 3, 1
  v_lshl_add_u32 v3, v4, 3, v3
  v_bfe_u32 v4, v1, 2, 1
  v_add_u32 v3, v3, v4
  v_lshlrev_b32 v3, 1, v3
  s_lshl_b32 s40, s27, 7
  s_add_u32 s40, s40, 524288
  buffer_load_ushort v40, v3, s[36:39], s40 offen offset:0
  buffer_load_ushort v41, v3, s[36:39], s40 offen offset:4
  buffer_load_ushort v42, v3, s[36:39], s40 offen offset:8
  buffer_load_ushort v43, v3, s[36:39], s40 offen offset:12
  v_bfe_u32 v4, v1, 4, 1
  v_lshrrev_b32 v5, 5, v1
  v_cmp_eq_u32 vcc, v4, v5
  v_mov_b32 v4, 0xbfb8aa3b
  v_lshlrev_b32 v3, 3, v1
  s_lshl_b32 s40, s27, 9
  s_add_u32 s40, s40, 21233664
  s_waitcnt vmcnt(0)
  v_lshlrev_b32 v40, 16, v40
  v_mul_f32 v40, v40, v4
  v_lshlrev_b32 v41, 16, v41
  v_mul_f32 v41, v41, v4
  v_lshlrev_b32 v42, 16, v42
  v_mul_f32 v42, v42, v4
  v_lshlrev_b32 v43, 16, v43
  v_mul_f32 v43, v43, v4
  v_cvt_pk_bf16_f32 v44, v40, v41
  v_cvt_pk_bf16_f32 v45, v42, v43
  v_cndmask_b32 v44, 0, v44, vcc
  v_cndmask_b32 v45, 0, v45, vcc
  buffer_store_dwordx2 v[44:45], v3, s[32:35], s40 offen sc1
  s_endpgm
k1_prep_zero:
  v_lshrrev_b32 v3, 5, v1
  s_mov_b32 s40, 10485760
  v_mul_lo_u32 v3, v3, s40
  v_and_b32 v4, 31, v1
  v_lshl_add_u32 v3, v4, 2, v3
  s_mul_i32 s40, s27, 1310720
  s_add_u32 s40, s40, 1280000
  v_mov_b32 v4, 0
  buffer_store_dword v4, v3, s[32:35], s40 offen sc1
  s_endpgm
k1_sort:
  s_lshl_b32 s48, s27, 2
  s_add_u32 s48, s48, s3
  v_lshlrev_b32 v2, 3, v0
  v_lshlrev_b32 v3, 2, v0
  v_lshlrev_b32 v4, 4, v0
  s_mul_i32 s49, s48, 20000
  s_mul_i32 s50, s48, 10000
  v_lshlrev_b32 v96, 4, v1
  v_add_u32 v8, 55552, v96
  v_cmp_gt_u32 vcc, 48, v1
  v_mov_b32 v100, 0
  s_nop 0
  v_cndmask_b32 v97, v8, v96, vcc
  v_cmp_gt_u32 vcc, 32, v1
  v_mov_b32 v101, 0
  s_nop 0
  v_cndmask_b32 v98, v8, v96, vcc
  v_cmp_gt_u32 vcc, 16, v1
  v_mov_b32 v102, 0
  s_nop 0
  v_cndmask_b32 v99, v8, v96, vcc
  v_mov_b32 v103, 0
  s_mul_i32 s55, s26, 7168
  v_add_u32 v7, s55, v96
  s_mul_i32 s59, s26, 229376
  s_mul_i32 s51, s48, 1792
  s_add_u32 s59, s59, s51
  s_add_u32 s59, s59, 21237760
  s_mul_i32 s55, s48, 57344
  s_add_u32 s55, s55, 21237760
  s_waitcnt lgkmcnt(0)
  s_mov_b32 s28, s10
  s_mov_b32 s29, s11
  s_mov_b32 s30, 640000
  s_mov_b32 s31, 0x00020000
  s_mov_b32 s32, s8
  s_mov_b32 s33, s9
  s_mov_b32 s34, 640000
  s_mov_b32 s35, 0x00020000
  s_mov_b32 s36, s6
  s_mov_b32 s37, s7
  s_mov_b32 s38, 320000
  s_mov_b32 s39, 0x00020000
  buffer_load_dwordx2 v[16:17], v2, s[28:31], s49 offen
  buffer_load_dwordx2 v[26:27], v2, s[32:35], s49 offen
  buffer_load_dword v36, v3, s[36:39], s50 offen
  s_add_u32 s49, s49, 4096
  s_add_u32 s50, s50, 2048
  buffer_load_dwordx2 v[18:19], v2, s[28:31], s49 offen
  buffer_load_dwordx2 v[28:29], v2, s[32:35], s49 offen
  buffer_load_dword v37, v3, s[36:39], s50 offen
  s_add_u32 s49, s49, 4096
  s_add_u32 s50, s50, 2048
  buffer_load_dwordx2 v[20:21], v2, s[28:31], s49 offen
  buffer_load_dwordx2 v[30:31], v2, s[32:35], s49 offen
  buffer_load_dword v38, v3, s[36:39], s50 offen
  s_add_u32 s49, s49, 4096
  s_add_u32 s50, s50, 2048
  buffer_load_dwordx2 v[22:23], v2, s[28:31], s49 offen
  buffer_load_dwordx2 v[32:33], v2, s[32:35], s49 offen
  buffer_load_dword v39, v3, s[36:39], s50 offen
  s_add_u32 s49, s49, 4096
  s_add_u32 s50, s50, 2048
  buffer_load_dwordx2 v[24:25], v2, s[28:31], s49 offen
  buffer_load_dwordx2 v[34:35], v2, s[32:35], s49 offen
  buffer_load_dword v40, v3, s[36:39], s50 offen
  s_add_u32 s49, s49, 4096
  s_add_u32 s50, s50, 2048
  s_mov_b32 s40, s24
  s_mov_b32 s41, s25
  s_mov_b32 s42, 24973312
  s_mov_b32 s43, 0x00020000
  s_mov_b32 s44, s22
  s_mov_b32 s45, s23
  s_mov_b32 s46, 128
  s_mov_b32 s47, 0x00020000
  v_mov_b32 v5, 1
  s_mov_b32 s51, 0xffff0000
  s_mov_b32 s52, -313
  s_brev_b32 s58, 1
  v_lshrrev_b32 v8, 6, v0
  v_cmp_eq_u32 vcc, 3, v8
  v_mov_b32 v9, 0
  v_lshlrev_b32 v6, 2, v1
  v_cndmask_b32 v8, 0, -1, vcc
  ds_write_b32 v3, v8
  ds_write_b32 v3, v9 offset:2048
  v_add_u32 v11, 8192, v6
  ds_write_b32 v3, v11 offset:4096
  v_add_u32 v69, 2147484928, v6
  v_mov_b32 v68, 0
  v_mov_b32 v70, 0
  v_mov_b32 v71, v69
  ds_write_b128 v4, v[68:71] offset:12288
  ds_write_b128 v4, v[68:71] offset:20480
  ds_write_b128 v4, v[68:71] offset:28672
  ds_write_b128 v4, v[68:71] offset:36864
  ds_write_b128 v4, v[68:71] offset:45056
  ds_write_b128 v4, v[68:71] offset:53248
  ds_write_b128 v4, v[68:71] offset:61440
  s_waitcnt lgkmcnt(0)
  s_barrier
  s_waitcnt vmcnt(12)
  s_add_u32 s49, s59, 0
  buffer_store_dwordx4 v[100:103], v96, s[40:43], s49 offen sc1
  v_mul_u32_u24 v42, 13401, v16
  v_lshrrev_b32 v42, 22, v42
  v_lshlrev_b32 v8, 2, v42
  ds_add_rtn_u32 v52, v8, v5 offset:0
  v_mad_i32_i24 v69, v42, s52, v16
  v_lshl_or_b32 v69, v69, 2, s58
  v_mul_u32_u24 v42, 1792, v42
  v_lshl_or_b32 v68, v36, 16, v26
  s_add_u32 s49, s59, 1024
  buffer_store_dwordx4 v[100:103], v97, s[40:43], s49 offen sc1
  v_mul_u32_u24 v43, 13401, v17
  v_lshrrev_b32 v43, 22, v43
  v_lshlrev_b32 v9, 2, v43
  ds_add_rtn_u32 v53, v9, v5 offset:0
  v_mad_i32_i24 v71, v43, s52, v17
  v_lshl_or_b32 v71, v71, 2, s58
  v_mul_u32_u24 v43, 1792, v43
  v_and_or_b32 v70, v36, s51, v27
  s_waitcnt vmcnt(11)
  s_add_u32 s49, s59, 57600
  buffer_store_dwordx4 v[100:103], v96, s[40:43], s49 offen sc1
  v_mul_u32_u24 v44, 13401, v18
  v_lshrrev_b32 v44, 22, v44
  v_lshlrev_b32 v8, 2, v44
  ds_add_rtn_u32 v54, v8, v5 offset:0
  v_mad_i32_i24 v73, v44, s52, v18
  v_lshl_or_b32 v73, v73, 2, s58
  v_mul_u32_u24 v44, 1792, v44
  v_lshl_or_b32 v72, v37, 16, v28
  s_add_u32 s49, s59, 58624
  buffer_store_dwordx4 v[100:103], v98, s[40:43], s49 offen sc1
  v_mul_u32_u24 v45, 13401, v19
  v_lshrrev_b32 v45, 22, v45
  v_lshlrev_b32 v9, 2, v45
  ds_add_rtn_u32 v55, v9, v5 offset:0
  v_mad_i32_i24 v75, v45, s52, v19
  v_lshl_or_b32 v75, v75, 2, s58
  v_mul_u32_u24 v45, 1792, v45
  v_and_or_b32 v74, v37, s51, v29
  s_waitcnt vmcnt(10)
  s_add_u32 s49, s59, 115200
  buffer_store_dwordx4 v[100:103], v96, s[40:43], s49 offen sc1
  v_mul_u32_u24 v46, 13401, v20
  v_lshrrev_b32 v46, 22, v46
  v_lshlrev_b32 v8, 2, v46
  ds_add_rtn_u32 v56, v8, v5 offset:0
  v_mad_i32_i24 v77, v46, s52, v20
  v_lshl_or_b32 v77, v77, 2, s58
  v_mul_u32_u24 v46, 1792, v46
  v_lshl_or_b32 v76, v38, 16, v30
  s_add_u32 s49, s59, 116224
  buffer_store_dwordx4 v[100:103], v99, s[40:43], s49 offen sc1
  v_mul_u32_u24 v47, 13401, v21
  v_lshrrev_b32 v47, 22, v47
  v_lshlrev_b32 v9, 2, v47
  ds_add_rtn_u32 v57, v9, v5 offset:0
  v_mad_i32_i24 v79, v47, s52, v21
  v_lshl_or_b32 v79, v79, 2, s58
  v_mul_u32_u24 v47, 1792, v47
  v_and_or_b32 v78, v38, s51, v31
  s_waitcnt vmcnt(9)
  v_mul_u32_u24 v48, 13401, v22
  v_lshrrev_b32 v48, 22, v48
  v_lshlrev_b32 v8, 2, v48
  ds_add_rtn_u32 v58, v8, v5 offset:0
  v_mad_i32_i24 v81, v48, s52, v22
  v_lshl_or_b32 v81, v81, 2, s58
  v_mul_u32_u24 v48, 1792, v48
  v_lshl_or_b32 v80, v39, 16, v32
  s_add_u32 s49, s59, 172800
  buffer_store_dwordx4 v[100:103], v96, s[40:43], s49 offen sc1
  v_mul_u32_u24 v49, 13401, v23
  v_lshrrev_b32 v49, 22, v49
  v_lshlrev_b32 v9, 2, v49
  ds_add_rtn_u32 v59, v9, v5 offset:0
  v_mad_i32_i24 v83, v49, s52, v23
  v_lshl_or_b32 v83, v83, 2, s58
  v_mul_u32_u24 v49, 1792, v49
  v_and_or_b32 v82, v39, s51, v33
  s_waitcnt vmcnt(7)
  v_cmp_gt_u32 vcc, 452, v0
  s_and_saveexec_b64 s[56:57], vcc
  v_mul_u32_u24 v50, 13401, v24
  v_lshrrev_b32 v50, 22, v50
  v_lshlrev_b32 v8, 2, v50
  ds_add_rtn_u32 v60, v8, v5 offset:0
  v_mad_i32_i24 v85, v50, s52, v24
  v_lshl_or_b32 v85, v85, 2, s58
  v_mul_u32_u24 v50, 1792, v50
  v_lshl_or_b32 v84, v40, 16, v34
  v_mul_u32_u24 v51, 13401, v25
  v_lshrrev_b32 v51, 22, v51
  v_lshlrev_b32 v9, 2, v51
  ds_add_rtn_u32 v61, v9, v5 offset:0
  v_mad_i32_i24 v87, v51, s52, v25
  v_lshl_or_b32 v87, v87, 2, s58
  v_mul_u32_u24 v51, 1792, v51
  v_and_or_b32 v86, v40, s51, v35
  s_mov_b64 exec, s[56:57]
  v_mov_b32 v10, 2147485184
  s_waitcnt lgkmcnt(9)
  v_cmp_lt_u32 vcc, 222, v52
  v_min_u32 v52, 223, v52
  v_lshl_add_u32 v42, v52, 3, v42
  v_cndmask_b32 v69, v69, v10, vcc
  ds_write_b64 v42, v[68:69] offset:12288
  s_waitcnt lgkmcnt(9)
  v_cmp_lt_u32 vcc, 222, v53
  v_min_u32 v53, 223, v53
  v_lshl_add_u32 v43, v53, 3, v43
  v_cndmask_b32 v71, v71, v10, vcc
  ds_write_b64 v43, v[70:71] offset:12288
  s_waitcnt lgkmcnt(9)
  v_cmp_lt_u32 vcc, 222, v54
  v_min_u32 v54, 223, v54
  v_lshl_add_u32 v44, v54, 3, v44
  v_cndmask_b32 v73, v73, v10, vcc
  ds_write_b64 v44, v[72:73] offset:12288
  s_waitcnt lgkmcnt(9)
  v_cmp_lt_u32 vcc, 222, v55
  v_min_u32 v55, 223, v55
  v_lshl_add_u32 v45, v55, 3, v45
  v_cndmask_b32 v75, v75, v10, vcc
  ds_write_b64 v45, v[74:75] offset:12288
  s_waitcnt lgkmcnt(9)
  v_cmp_lt_u32 vcc, 222, v56
  v_min_u32 v56, 223, v56
  v_lshl_add_u32 v46, v56, 3, v46
  v_cndmask_b32 v77, v77, v10, vcc
  ds_write_b64 v46, v[76:77] offset:12288
  s_waitcnt lgkmcnt(9)
  v_cmp_lt_u32 vcc, 222, v57
  v_min_u32 v57, 223, v57
  v_lshl_add_u32 v47, v57, 3, v47
  v_cndmask_b32 v79, v79, v10, vcc
  ds_write_b64 v47, v[78:79] offset:12288
  s_waitcnt lgkmcnt(9)
  v_cmp_lt_u32 vcc, 222, v58
  v_min_u32 v58, 223, v58
  v_lshl_add_u32 v48, v58, 3, v48
  v_cndmask_b32 v81, v81, v10, vcc
  ds_write_b64 v48, v[80:81] offset:12288
  s_waitcnt lgkmcnt(9)
  v_cmp_lt_u32 vcc, 222, v59
  v_min_u32 v59, 223, v59
  v_lshl_add_u32 v49, v59, 3, v49
  v_cndmask_b32 v83, v83, v10, vcc
  ds_write_b64 v49, v[82:83] offset:12288
  v_cmp_gt_u32 vcc, 452, v0
  s_and_saveexec_b64 s[56:57], vcc
  s_waitcnt lgkmcnt(9)
  v_cmp_lt_u32 vcc, 222, v60
  v_min_u32 v60, 223, v60
  v_lshl_add_u32 v50, v60, 3, v50
  v_cndmask_b32 v85, v85, v10, vcc
  ds_write_b64 v50, v[84:85] offset:12288
  s_waitcnt lgkmcnt(9)
  v_cmp_lt_u32 vcc, 222, v61
  v_min_u32 v61, 223, v61
  v_lshl_add_u32 v51, v61, 3, v51
  v_cndmask_b32 v87, v87, v10, vcc
  ds_write_b64 v51, v[86:87] offset:12288
  s_mov_b64 exec, s[56:57]
  s_lshl_b32 s50, s48, 2
  s_cmp_eq_u32 s26, 0
  s_cselect_b32 s50, s50, 0x1000
  s_waitcnt vmcnt(0) lgkmcnt(0)
  s_barrier
  s_mov_b64 exec, 1
  buffer_store_dword v5, off, s[44:47], s50 sc1
  s_mov_b64 exec, -1
  ds_read_b128 v[68:71], v7 offset:12288
  ds_read_b128 v[72:75], v7 offset:13312
  ds_read_b128 v[76:79], v7 offset:14336
  ds_read_b128 v[80:83], v7 offset:15360
  ds_read_b128 v[84:87], v7 offset:16384
  ds_read_b128 v[88:91], v7 offset:17408
  ds_read_b128 v[92:95], v7 offset:18432
  s_waitcnt lgkmcnt(6)
  s_add_u32 s49, s59, 0
  buffer_store_dwordx4 v[68:71], v96, s[40:43], s49 offen sc1
  s_waitcnt lgkmcnt(5)
  s_add_u32 s49, s59, 1024
  buffer_store_dwordx4 v[72:75], v97, s[40:43], s49 offen sc1
  s_waitcnt lgkmcnt(4)
  s_add_u32 s49, s59, 57600
  buffer_store_dwordx4 v[76:79], v96, s[40:43], s49 offen sc1
  s_waitcnt lgkmcnt(3)
  s_add_u32 s49, s59, 58624
  buffer_store_dwordx4 v[80:83], v98, s[40:43], s49 offen sc1
  s_waitcnt lgkmcnt(2)
  s_add_u32 s49, s59, 115200
  buffer_store_dwordx4 v[84:87], v96, s[40:43], s49 offen sc1
  s_waitcnt lgkmcnt(1)
  s_add_u32 s49, s59, 116224
  buffer_store_dwordx4 v[88:91], v99, s[40:43], s49 offen sc1
  s_waitcnt lgkmcnt(0)
  s_add_u32 s49, s59, 172800
  buffer_store_dwordx4 v[92:95], v96, s[40:43], s49 offen sc1
  s_lshl_b32 s59, s26, 4
  v_and_b32 v15, 12, v6
  v_add_u32 v12, 69632, v4
  v_mov_b32 v100, 10000
  v_mov_b32 v101, 10000
  v_mov_b32 v102, 10000
  v_mov_b32 v103, 10000
  ds_write_b128 v12, v[100:103] offset:0
  ds_write_b128 v12, v[100:103] offset:8192
  ds_write_b128 v12, v[100:103] offset:16384
  ds_write_b128 v12, v[100:103] offset:24576
  ds_write_b128 v12, v[100:103] offset:32768
  ds_write_b128 v12, v[100:103] offset:40960
  s_mul_i32 s54, s48, 313
  s_sub_u32 s53, 10000, s54
  s_min_u32 s53, s53, 313
  s_mov_b32 s50, 0
k1_sort_cleared:
  buffer_load_dword v14, v15, s[44:47], s59 offen sc1
  s_add_u32 s50, s50, 1
  s_cmp_ge_u32 s50, 20000
  s_waitcnt vmcnt(0)
  v_cmp_eq_u32 vcc, 0, v14
  s_cbranch_vccz k1_sort_recv
  s_cbranch_scc0 k1_sort_cleared
  s_branch k1_sort_lost
k1_sort_recv:
  s_add_u32 s49, s55, 0
  buffer_load_dwordx4 v[68:71], v7, s[40:43], s49 offen sc1
  s_add_u32 s49, s55, 1024
  buffer_load_dwordx4 v[72:75], v7, s[40:43], s49 offen sc1
  s_add_u32 s49, s55, 2048
  buffer_load_dwordx4 v[76:79], v7, s[40:43], s49 offen sc1
  s_add_u32 s49, s55, 3072
  buffer_load_dwordx4 v[80:83], v7, s[40:43], s49 offen sc1
  s_add_u32 s49, s55, 4096
  buffer_load_dwordx4 v[84:87], v7, s[40:43], s49 offen sc1
  s_add_u32 s49, s55, 5120
  buffer_load_dwordx4 v[88:91], v7, s[40:43], s49 offen sc1
  s_add_u32 s49, s55, 6144
  buffer_load_dwordx4 v[92:95], v7, s[40:43], s49 offen sc1
  s_add_u32 s50, s50, 1
  s_cmp_ge_u32 s50, 20000
  v_mov_b32 v8, -1
  s_waitcnt vmcnt(6)
  v_and_b32 v8, v8, v69
  v_and_b32 v8, v8, v71
  s_waitcnt vmcnt(5)
  v_and_b32 v8, v8, v73
  v_and_b32 v8, v8, v75
  s_waitcnt vmcnt(4)
  v_and_b32 v8, v8, v77
  v_and_b32 v8, v8, v79
  s_waitcnt vmcnt(3)
  v_and_b32 v8, v8, v81
  v_and_b32 v8, v8, v83
  s_waitcnt vmcnt(2)
  v_and_b32 v8, v8, v85
  v_and_b32 v8, v8, v87
  s_waitcnt vmcnt(1)
  v_and_b32 v8, v8, v89
  v_and_b32 v8, v8, v91
  s_waitcnt vmcnt(0)
  v_and_b32 v8, v8, v93
  v_and_b32 v8, v8, v95
  v_cmp_le_i32 vcc, 0, v8
  s_cbranch_vccz k1_sort_got
  s_cbranch_scc0 k1_sort_recv
k1_sort_lost:
  v_mov_b32 v69, 1536
  v_mov_b32 v71, 1536
  v_mov_b32 v73, 1536
  v_mov_b32 v75, 1536
  v_mov_b32 v77, 1536
  v_mov_b32 v79, 1536
  v_mov_b32 v81, 1536
  v_mov_b32 v83, 1536
  v_mov_b32 v85, 1536
  v_mov_b32 v87, 1536
  v_mov_b32 v89, 1536
  v_mov_b32 v91, 1536
  v_mov_b32 v93, 1536
  v_mov_b32 v95, 1536
k1_sort_got:
  v_and_b32 v69, 0xfff, v69
  ds_add_rtn_u32 v52, v69, v5 offset:1024
  v_and_b32 v71, 0xfff, v71
  ds_add_rtn_u32 v53, v71, v5 offset:1024
  v_and_b32 v73, 0xfff, v73
  ds_add_rtn_u32 v54, v73, v5 offset:1024
  v_and_b32 v75, 0xfff, v75
  ds_add_rtn_u32 v55, v75, v5 offset:1024
  v_and_b32 v77, 0xfff, v77
  ds_add_rtn_u32 v56, v77, v5 offset:1024
  v_and_b32 v79, 0xfff, v79
  ds_add_rtn_u32 v57, v79, v5 offset:1024
  v_and_b32 v81, 0xfff, v81
  ds_add_rtn_u32 v58, v81, v5 offset:1024
  v_and_b32 v83, 0xfff, v83
  ds_add_rtn_u32 v59, v83, v5 offset:1024
  v_and_b32 v85, 0xfff, v85
  ds_add_rtn_u32 v60, v85, v5 offset:1024
  v_and_b32 v87, 0xfff, v87
  ds_add_rtn_u32 v61, v87, v5 offset:1024
  v_and_b32 v89, 0xfff, v89
  ds_add_rtn_u32 v62, v89, v5 offset:1024
  v_and_b32 v91, 0xfff, v91
  ds_add_rtn_u32 v63, v91, v5 offset:1024
  v_and_b32 v93, 0xfff, v93
  ds_add_rtn_u32 v64, v93, v5 offset:1024
  v_and_b32 v95, 0xfff, v95
  ds_add_rtn_u32 v65, v95, v5 offset:1024
  s_waitcnt lgkmcnt(0)
  s_barrier
  s_cmp_ge_u32 s26, 5
  s_cbranch_scc1 k1_sort_s1
  ds_read_b32 v16, v3 offset:1024
  s_waitcnt lgkmcnt(0)
  v_min_u32 v17, 63, v16
  v_sub_u32 v17, 63, v17
  v_lshlrev_b32 v17, 2, v17
  ds_add_rtn_u32 v18, v17, v5 offset:256
  s_waitcnt lgkmcnt(0)
k1_sort_s1:
  s_barrier
  s_cmp_ge_u32 s26, 5
  s_cbranch_scc1 k1_sort_s2
  v_lshlrev_b32 v8, 2, v1
  ds_read_b32 v9, v8 offset:256
  s_waitcnt lgkmcnt(0)
  v_mov_b32 v10, v9
  s_nop 1
  v_add_u32_dpp v10, v10, v10 row_shr:1 row_mask:0xf bank_mask:0xf bound_ctrl:1
  s_nop 1
  v_add_u32_dpp v10, v10, v10 row_shr:2 row_mask:0xf bank_mask:0xf bound_ctrl:1
  s_nop 1
  v_add_u32_dpp v10, v10, v10 row_shr:4 row_mask:0xf bank_mask:0xf bound_ctrl:1
  s_nop 1
  v_add_u32_dpp v10, v10, v10 row_shr:8 row_mask:0xf bank_mask:0xf bound_ctrl:1
  s_nop 1
  v_add_u32_dpp v10, v10, v10 row_bcast:15 row_mask:0xa bank_mask:0xf
  s_nop 1
  v_add_u32_dpp v10, v10, v10 row_bcast:31 row_mask:0xc bank_mask:0xf
  v_sub_u32 v10, v10, v9
  ds_bpermute_b32 v19, v17, v10
  s_waitcnt lgkmcnt(0)
  v_add_u32 v19, v19, v18
  v_lshrrev_b32 v20, 3, v19
  v_and_b32 v21, 7, v19
  v_lshlrev_b32 v8, 2, v20
  ds_max_u32 v8, v16 offset:512
  v_cmp_gt_u32 vcc, s53, v0
  s_nop 1
  v_cndmask_b32 v9, -1, v16, vcc
  ds_min_u32 v8, v9 offset:768
  v_lshrrev_b32 v22, 3, v20
  v_mov_b32 v24, 1985229328
  v_cmp_eq_u32 vcc, 1, v22
  v_mov_b32 v9, 103884103
  s_nop 0
  v_cndmask_b32 v24, v24, v9, vcc
  v_cmp_eq_u32 vcc, 2, v22
  v_mov_b32 v9, 118641763
  s_nop 0
  v_cndmask_b32 v24, v24, v9, vcc
  v_cmp_eq_u32 vcc, 3, v22
  v_mov_b32 v9, 52892758
  s_nop 0
  v_cndmask_b32 v24, v24, v9, vcc
  v_cmp_eq_u32 vcc, 4, v22
  v_mov_b32 v9, 21123943
  s_nop 0
  v_cndmask_b32 v24, v24, v9, vcc
  s_waitcnt lgkmcnt(0)
k1_sort_s2:
  s_barrier
  s_cmp_ge_u32 s26, 5
  s_cbranch_scc1 k1_sort_s3
  ds_read_b32 v31, v8 offset:512
  ds_read_b32 v32, v8 offset:768
  v_mov_b32 v11, 2560
  ds_read_b32 v33, v11
  v_and_b32 v10, 28, v8
  v_bfe_u32 v23, v24, v10, 3
  v_lshlrev_b32 v9, 2, v23
  ds_read_b32 v26, v9 offset:512
  s_mov_b32 s49, 102847303
  v_bfe_u32 v10, s49, v9, 3
  v_lshlrev_b32 v10, 2, v10
  ds_read_b32 v27, v10 offset:544
  s_mov_b32 s49, 1630667863
  v_bfe_u32 v10, s49, v9, 3
  v_lshlrev_b32 v10, 2, v10
  ds_read_b32 v28, v10 offset:576
  s_mov_b32 s49, 1074947383
  v_bfe_u32 v10, s49, v9, 3
  v_lshlrev_b32 v10, 2, v10
  ds_read_b32 v29, v10 offset:608
  s_mov_b32 s49, 20259943
  v_bfe_u32 v10, s49, v9, 3
  v_lshlrev_b32 v10, 2, v10
  ds_read_b32 v30, v10 offset:640
  v_mov_b32 v12, 0
  v_mov_b32 v13, 0
  s_waitcnt lgkmcnt(0)
  v_lshlrev_b32 v15, 2, v22
  v_mov_b32 v14, 0x31420
  v_lshrrev_b32 v15, v15, v14
  v_and_b32 v15, 15, v15
  v_add_u32 v26, 1, v26
  v_lshrrev_b32 v26, 1, v26
  v_cmp_lt_u32 vcc, 0, v15
  v_max_u32 v26, 1, v26
  v_add_u32 v13, v13, v26
  v_cndmask_b32 v14, 0, v26, vcc
  v_add_u32 v12, v12, v14
  v_add_u32 v27, 1, v27
  v_lshrrev_b32 v27, 1, v27
  v_cmp_lt_u32 vcc, 2, v15
  v_max_u32 v27, 1, v27
  v_add_u32 v13, v13, v27
  v_cndmask_b32 v14, 0, v27, vcc
  v_add_u32 v12, v12, v14
  v_add_u32 v28, 1, v28
  v_lshrrev_b32 v28, 1, v28
  v_cmp_lt_u32 vcc, 4, v15
  v_max_u32 v28, 1, v28
  v_add_u32 v13, v13, v28
  v_cndmask_b32 v14, 0, v28, vcc
  v_add_u32 v12, v12, v14
  v_add_u32 v29, 1, v29
  v_lshrrev_b32 v29, 1, v29
  v_cmp_lt_u32 vcc, 1, v15
  v_max_u32 v29, 1, v29
  v_add_u32 v13, v13, v29
  v_cndmask_b32 v14, 0, v29, vcc
  v_add_u32 v12, v12, v14
  v_add_u32 v30, 1, v30
  v_lshrrev_b32 v30, 1, v30
  v_cmp_lt_u32 vcc, 3, v15
  v_max_u32 v30, 1, v30
  v_add_u32 v13, v13, v30
  v_cndmask_b32 v14, 0, v30, vcc
  v_add_u32 v12, v12, v14
  v_cmp_lt_u32 vcc, 64, v13
  v_mov_b32 v11, 132
  s_cbranch_vccz k1_sort_short
  ds_write_b32 v11, v5
k1_sort_short:
  v_cmp_lt_u32 vcc, 79, v13
  v_cmp_ne_u32 s[56:57], 0, v33
  s_or_b64 vcc, vcc, s[56:57]
  s_cbranch_vccz k1_sort_ok
  v_mov_b32 v11, 128
  ds_write_b32 v11, v5
k1_sort_ok:
  v_mul_u32_u24 v9, 6144, v23
  v_add_u32 v9, 69632, v9
  v_lshl_add_u32 v10, v21, 2, v9
  v_lshl_add_u32 v11, v12, 6, v10
  v_add_u32 v11, 256, v11
  ds_write_b32 v3, v11 offset:3072
  v_cmp_gt_u32 vcc, s53, v0
  v_add_u32 v11, s54, v0
  v_mov_b32 v14, 10000
  v_cndmask_b32 v11, v14, v11, vcc
  v_lshl_or_b32 v11, v16, 16, v11
  v_lshl_add_u32 v10, v22, 5, v10
  ds_write_b32 v10, v11
  v_max_u32 v31, 1, v31
  v_and_b32 v14, 1, v31
  v_subrev_u32 v31, 1, v31
  v_lshrrev_b32 v31, 1, v31
  v_lshrrev_b32 v32, 1, v32
  v_cmp_lt_u32 vcc, v32, v31
  v_cmp_gt_u32 s[56:57], 2, v31
  v_lshl_or_b32 v12, v12, 10, v31
  s_or_b64 vcc, vcc, s[56:57]
  v_lshl_or_b32 v12, v14, 8, v12
  v_cndmask_b32 v14, 0, 1, vcc
  v_lshl_or_b32 v12, v14, 9, v12
  v_lshl_add_u32 v9, v22, 2, v9
  ds_write_b32 v9, v12 offset:192
  s_waitcnt lgkmcnt(0)
k1_sort_s3:
  s_barrier
  s_mul_i32 s50, s26, 6144
  s_add_u32 s59, s50, 69632
  v_lshrrev_b32 v10, 4, v1
  v_lshl_add_u32 v10, v10, 2, s59
  v_mov_b32 v11, s59
  ds_read_b32 v10, v10 offset:192
  ds_read_b32 v11, v11 offset:208
  v_mov_b32 v8, 128
  ds_read_b64 v[8:9], v8
  ds_read_b32 v42, v69 offset:3072
  ds_read_b32 v43, v71 offset:3072
  ds_read_b32 v44, v73 offset:3072
  ds_read_b32 v45, v75 offset:3072
  ds_read_b32 v46, v77 offset:3072
  ds_read_b32 v47, v79 offset:3072
  ds_read_b32 v48, v81 offset:3072
  ds_read_b32 v49, v83 offset:3072
  ds_read_b32 v50, v85 offset:3072
  ds_read_b32 v51, v87 offset:3072
  ds_read_b32 v36, v89 offset:3072
  ds_read_b32 v37, v91 offset:3072
  ds_read_b32 v38, v93 offset:3072
  ds_read_b32 v39, v95 offset:3072
  s_waitcnt lgkmcnt(14)
  v_readfirstlane_b32 s50, v8
  v_readfirstlane_b32 s51, v9
  s_cmp_lg_u32 s50, 0
  s_cbranch_scc1 k1_sort_s4
  s_waitcnt lgkmcnt(13)
  v_lshl_add_u32 v42, v52, 5, v42
  ds_write_b32 v42, v68
  s_waitcnt lgkmcnt(13)
  v_lshl_add_u32 v43, v53, 5, v43
  ds_write_b32 v43, v70
  s_waitcnt lgkmcnt(13)
  v_lshl_add_u32 v44, v54, 5, v44
  ds_write_b32 v44, v72
  s_waitcnt lgkmcnt(13)
  v_lshl_add_u32 v45, v55, 5, v45
  ds_write_b32 v45, v74
  s_waitcnt lgkmcnt(13)
  v_lshl_add_u32 v46, v56, 5, v46
  ds_write_b32 v46, v76
  s_waitcnt lgkmcnt(13)
  v_lshl_add_u32 v47, v57, 5, v47
  ds_write_b32 v47, v78
  s_waitcnt lgkmcnt(13)
  v_lshl_add_u32 v48, v58, 5, v48
  ds_write_b32 v48, v80
  s_waitcnt lgkmcnt(13)
  v_lshl_add_u32 v49, v59, 5, v49
  ds_write_b32 v49, v82
  s_waitcnt lgkmcnt(13)
  v_lshl_add_u32 v50, v60, 5, v50
  ds_write_b32 v50, v84
  s_waitcnt lgkmcnt(13)
  v_lshl_add_u32 v51, v61, 5, v51
  ds_write_b32 v51, v86
  s_waitcnt lgkmcnt(13)
  v_lshl_add_u32 v36, v62, 5, v36
  ds_write_b32 v36, v88
  s_waitcnt lgkmcnt(13)
  v_lshl_add_u32 v37, v63, 5, v37
  ds_write_b32 v37, v90
  s_waitcnt lgkmcnt(13)
  v_lshl_add_u32 v38, v64, 5, v38
  ds_write_b32 v38, v92
  s_waitcnt lgkmcnt(13)
  v_lshl_add_u32 v39, v65, 5, v39
  ds_write_b32 v39, v94
k1_sort_s4:
  v_mov_b32 v9, s59
  ds_write_b32 v9, v8 offset:212
  v_add_u32 v9, s59, v96
  v_and_b32 v13, 60, v6
  v_add_u32 v13, s59, v13
  v_and_b32 v12, 0x300, v96
  v_add_u32 v12, v12, v13
  v_bfe_u32 v10, v10, 10, 7
  v_bfe_u32 v11, v11, 10, 7
  v_lshl_add_u32 v10, v10, 6, v13
  v_lshl_add_u32 v11, v11, 6, v13
  s_lshl_b32 s50, s48, 3
  s_add_u32 s50, s50, s26
  s_mul_i32 s49, s50, 6144
  s_add_u32 s49, s49, 23072768
  s_mul_i32 s50, s50, 1280
  s_add_u32 s50, s50, 24645632
  s_cmp_eq_u32 s51, 0
  s_waitcnt lgkmcnt(0)
  s_barrier
  ds_read2_b32 v[68:69], v10 offset0:64 offset1:80
  ds_read2_b32 v[70:71], v10 offset0:96 offset1:112
  ds_read2_b32 v[72:73], v11 offset0:64 offset1:80
  ds_read2_b32 v[74:75], v11 offset0:96 offset1:112
  ds_read_b128 v[76:79], v9
  ds_read2_b32 v[80:81], v12 offset0:64 offset1:80
  ds_read2_b32 v[82:83], v12 offset0:96 offset1:112
  v_add_u32 v12, 1024, v12
  ds_read2_b32 v[84:85], v12 offset0:64 offset1:80
  ds_read2_b32 v[86:87], v12 offset0:96 offset1:112
  v_add_u32 v12, 1024, v12
  ds_read2_b32 v[88:89], v12 offset0:64 offset1:80
  ds_read2_b32 v[90:91], v12 offset0:96 offset1:112
  v_add_u32 v12, 1024, v12
  ds_read2_b32 v[92:93], v12 offset0:64 offset1:80
  ds_read2_b32 v[94:95], v12 offset0:96 offset1:112
  v_add_u32 v12, 1024, v12
  s_waitcnt lgkmcnt(8)
  buffer_store_dwordx4 v[68:71], v96, s[40:43], s50 offen sc1
  s_mov_b64 exec, 0xffff
  buffer_store_dwordx4 v[72:75], v96, s[40:43], s50 offen offset:1024 sc1
  buffer_store_dwordx4 v[76:79], v96, s[40:43], s49 offen sc1
  s_mov_b64 exec, -1
  s_waitcnt lgkmcnt(6)
  buffer_store_dwordx4 v[80:83], v96, s[40:43], s49 offen offset:256 sc1
  s_waitcnt lgkmcnt(4)
  buffer_store_dwordx4 v[84:87], v96, s[40:43], s49 offen offset:1280 sc1
  s_waitcnt lgkmcnt(2)
  buffer_store_dwordx4 v[88:91], v96, s[40:43], s49 offen offset:2304 sc1
  s_waitcnt lgkmcnt(0)
  buffer_store_dwordx4 v[92:95], v96, s[40:43], s49 offen offset:3328 sc1
  s_cbranch_scc1 k1_sort_end
  s_add_u32 s49, s49, 4096
  ds_read2_b32 v[100:101], v12 offset0:64 offset1:80
  ds_read2_b32 v[102:103], v12 offset0:96 offset1:112
  s_waitcnt lgkmcnt(0)
  buffer_store_dwordx4 v[100:103], v96, s[40:43], s49 offen offset:256 sc1
k1_sort_end:
  s_endpgm
k1_exit:
  s_endpgm
.globl mpnn_edge_kernel
.p2align 8
.type mpnn_edge_kernel,@function
mpnn_edge_kernel:
  s_cmp_ge_u32 s2, 256
  s_cbranch_scc1 k2_exit
  s_load_dwordx16 s[4:19], s[0:1], 0
  s_load_dwordx4 s[20:23], s[0:1], 64
  s_load_dwordx2 s[24:25], s[0:1], 80
  v_readfirstlane_b32 s26, v0
  v_and_b32 v1, 63, v0
  s_lshr_b32 s26, s26, 6
  s_mul_i32 s94, s2, 6144
  s_add_u32 s94, s94, 23072768
  v_and_b32 v13, 60, v1
  v_lshlrev_b32 v13, 2, v13
  v_and_b32 v84, 28, v1
  v_lshlrev_b32 v6, 3, v1
  v_lshlrev_b32 v85, 2, v1
  s_lshl_b32 s88, s26, 8
  s_add_u32 s90, s94, s88
  s_add_u32 s91, s90, 4096
  s_add_u32 s88, s26, 0
  s_mul_i32 s89, s88, 13
  s_lshr_b32 s89, s89, 6
  s_mul_i32 s76, s89, 1310720
  s_lshl_b32 s82, s89, 25
  s_mul_i32 s89, s89, 5
  s_sub_u32 s70, s88, s89
  s_mul_i32 s88, s2, 1280
  s_lshl_b32 s89, s70, 8
  s_add_u32 s93, s88, s89
  s_add_u32 s93, s93, 24645632
  s_waitcnt lgkmcnt(0)
  s_mov_b32 s36, s24
  s_mov_b32 s37, s25
  s_mov_b32 s38, 24973312
  s_mov_b32 s39, 0x00020000
  buffer_load_dwordx4 v[88:91], v13, s[36:39], s93 offen
  buffer_load_dword v40, v85, s[36:39], s94 offen
  buffer_load_dwordx4 v[28:31], v13, s[36:39], s90 offen offset:256
  buffer_load_dwordx4 v[32:35], v13, s[36:39], s90 offen offset:2304
  buffer_load_dwordx4 v[36:39], v13, s[36:39], s91 offen offset:256
  s_lshl_b32 s90, s26, 9
  s_add_u32 s89, s90, 21233664
  buffer_load_dwordx2 v[42:43], v6, s[36:39], s89 offen
  s_mov_b32 s44, s18
  s_mov_b32 s45, s19
  s_mov_b32 s46, 512
  s_mov_b32 s47, 0x00020000
  s_lshl_b32 s89, s26, 6
  v_and_b32 v10, 15, v1
  v_lshlrev_b32 v10, 2, v10
  v_add_u32 v10, s89, v10
  buffer_load_dword v11, v10, s[44:47], 0 offen
  s_add_u32 s88, s26, 8
  s_mul_i32 s89, s88, 13
  s_lshr_b32 s89, s89, 6
  s_mul_i32 s77, s89, 1310720
  s_lshl_b32 s83, s89, 25
  s_mul_i32 s89, s89, 5
  s_sub_u32 s71, s88, s89
  s_add_u32 s88, s26, 16
  s_mul_i32 s89, s88, 13
  s_lshr_b32 s89, s89, 6
  s_mul_i32 s78, s89, 1310720
  s_lshl_b32 s84, s89, 25
  s_mul_i32 s89, s89, 5
  s_sub_u32 s72, s88, s89
  s_add_u32 s88, s26, 24
  s_mul_i32 s89, s88, 13
  s_lshr_b32 s89, s89, 6
  s_mul_i32 s79, s89, 1310720
  s_lshl_b32 s85, s89, 25
  s_mul_i32 s89, s89, 5
  s_sub_u32 s73, s88, s89
  s_add_u32 s88, s26, 32
  s_mul_i32 s89, s88, 13
  s_lshr_b32 s89, s89, 6
  s_mul_i32 s80, s89, 1310720
  s_lshl_b32 s86, s89, 25
  s_mul_i32 s89, s89, 5
  s_sub_u32 s74, s88, s89
  s_mov_b32 s28, s24
  s_mov_b32 s29, s25
  s_mov_b32 s30, 10485760
  s_mov_b32 s31, 0x00020000
  s_add_u32 s32, s24, 10485760
  s_addc_u32 s33, s25, 0
  s_mov_b32 s34, 10485760
  s_mov_b32 s35, 0x00020000
  s_mov_b32 s40, s20
  s_mov_b32 s41, s21
  s_mov_b32 s42, 5120000
  s_mov_b32 s43, 0x00020000
  s_movk_i32 s95, 128
  v_and_b32 v62, 3, v1
  v_lshlrev_b32 v2, 4, v62
  v_and_b32 v60, 1, v1
  v_cmp_eq_u32 vcc, 0, v60
  v_mov_b32 v64, 0x03020c0c
  v_mov_b32 v65, 0x0c0c0302
  v_mov_b32 v66, 0x0c0c0c0c
  v_cndmask_b32 v64, v64, v65, vcc
  v_cmp_gt_u32 vcc, 2, v62
  s_mov_b32 s17, s76
  s_mov_b32 s16, s76
  v_cndmask_b32 v60, v66, v64, vcc
  v_cndmask_b32 v61, v64, v66, vcc
  s_lshl_b32 s88, s70, 5
  v_add_u32 v18, s88, v84
  s_lshl_b32 s88, s71, 5
  v_add_u32 v19, s88, v84
  s_lshl_b32 s88, s72, 5
  v_add_u32 v20, s88, v84
  s_lshl_b32 s88, s73, 5
  v_add_u32 v21, s88, v84
  s_lshl_b32 s88, s74, 5
  v_add_u32 v22, s88, v84
  s_getpc_b64 s[8:9]
k2_pcbase:
  s_waitcnt vmcnt(6)
  v_mad_u32_u16 v148, v88, s95, v2
  v_mad_u32_u16 v152, v89, s95, v2
  v_mad_u32_u16 v156, v90, s95, v2
  v_mad_u32_u16 v160, v91, s95, v2
  buffer_load_dwordx4 v[116:119], v148, s[28:31], s16 offen offset:0
  buffer_load_dwordx4 v[120:123], v148, s[28:31], s16 offen offset:64
  s_waitcnt vmcnt(7)
  ds_bpermute_b32 v18, v18, v40
  ds_bpermute_b32 v19, v19, v40
  ds_bpermute_b32 v20, v20, v40
  ds_bpermute_b32 v21, v21, v40
  ds_bpermute_b32 v22, v22, v40
  v_readlane_b32 s56, v40, 48
  v_readlane_b32 s57, v40, 49
  v_readlane_b32 s58, v40, 50
  v_readlane_b32 s59, v40, 51
  v_readlane_b32 s60, v40, 52
  v_readlane_b32 s61, v40, 53
  s_waitcnt lgkmcnt(4)
  v_mad_u32_u16 v13, v18, s95, v2
  buffer_load_dwordx4 v[164:167], v13, s[32:35], s17 offen offset:0
  buffer_load_dwordx4 v[168:171], v13, s[32:35], s17 offen offset:64
  s_lshl_b32 s92, s26, 15
  s_add_u32 s92, s92, 20971520
  v_lshlrev_b32 v4, 4, v1
  v_mov_b32 v12, 1
  v_add_u32 v6, 86016, v6
  v_add_u32 v7, s90, v6
  v_lshlrev_b32 v15, 2, v0
  v_mov_b32 v9, 0
  ds_write_b32 v15, v9 offset:2048
  v_add_u32 v15, 2560, v85
  v_mul_u32_u24 v5, 260, v84
  v_add_u32 v5, v5, v2
  v_lshrrev_b32 v63, 5, v1
  v_lshl_add_u32 v5, v63, 3, v5
  v_add_u32 v5, 90112, v5
  v_and_b32 v240, 15, v1
  v_mul_u32_u24 v240, 1040, v240
  v_and_b32 v64, 48, v1
  v_add_u32 v240, v240, v64
  v_add_u32 v240, 90112, v240
  v_and_b32 v241, 7, v1
  v_mul_u32_u24 v241, 1040, v241
  v_lshl_add_u32 v241, v64, 1, v241
  v_bfe_u32 v65, v1, 3, 1
  v_lshl_add_u32 v241, v65, 2, v241
  v_add_u32 v241, 123392, v241
  v_mul_u32_u24 v242, 0xaaaa, v65
  v_add_u32 v242, 0x4444, v242
  s_lshl_b32 s88, s26, 12
  s_add_u32 s88, s88, 4096
  v_add_u32 v14, s88, v4
  v_bfe_u32 v64, v1, 3, 1
  v_cmp_eq_u32 vcc, v64, v63
  v_bfe_u32 v65, v1, 4, 1
  v_bfe_u32 v66, v1, 2, 1
  v_lshl_add_u32 v65, v65, 1, v66
  v_cndmask_b32 v64, 7, v65, vcc
  v_mov_b32 v68, 0x3f80
  v_mul_u32_u24 v178, 0x5555, v62
  v_mov_b32 v176, 0
  v_mov_b32 v177, 0
  v_cmp_eq_u32 vcc, 0, v64
  s_nop 1
  v_cndmask_b32 v172, 0, v68, vcc
  v_cmp_eq_u32 vcc, 1, v64
  s_nop 1
  v_cndmask_b32 v173, 0, v68, vcc
  v_cmp_eq_u32 vcc, 2, v64
  s_nop 1
  v_cndmask_b32 v174, 0, v68, vcc
  v_cmp_eq_u32 vcc, 3, v64
  s_nop 1
  v_cndmask_b32 v175, 0, v68, vcc
  s_mul_i32 s18, s70, 8320
  s_lshr_b32 s89, s82, 18
  s_add_u32 s18, s18, s89
  s_mul_i32 s19, s71, 8320
  s_lshr_b32 s89, s83, 18
  s_add_u32 s19, s19, s89
  s_mul_i32 s20, s72, 8320
  s_lshr_b32 s89, s84, 18
  s_add_u32 s20, s20, s89
  s_mul_i32 s21, s73, 8320
  s_lshr_b32 s89, s85, 18
  s_add_u32 s21, s21, s89
  s_mul_i32 s22, s74, 8320
  s_lshr_b32 s89, s86, 18
  s_add_u32 s22, s22, s89
  s_mov_b32 s69, 1000
  s_mov_b32 s75, 4096
  s_mov_b32 s81, 0x7f000000
  s_mov_b32 s15, 0
  s_cmp_lg_u32 s61, 0
  s_cbranch_scc1 k2_slow_static
  s_and_b32 s88, s58, 0xff
  s_lshr_b32 s89, s58, 10
  s_add_u32 s91, s88, s89
  s_add_u32 s91, s91, 1
  s_lshl_b32 s93, s91, 10
  s_lshl_b32 s88, s26, 2
  s_sub_u32 s91, s91, s88
  v_perm_b32 v150, v88, v88, v60
  v_perm_b32 v151, v88, v88, v61
  v_perm_b32 v154, v89, v89, v60
  v_perm_b32 v155, v89, v89, v61
  v_perm_b32 v158, v90, v90, v60
  v_perm_b32 v159, v90, v90, v61
  v_perm_b32 v162, v91, v91, v60
  v_perm_b32 v163, v91, v91, v61
  s_waitcnt vmcnt(6)
  s_cmp_le_i32 s91, 0
  v_mad_u32_u16 v92, v28, s95, v2
  v_perm_b32 v94, v28, v28, v60
  v_perm_b32 v95, v28, v28, v61
  s_cbranch_scc1 k2_expanded
  ds_write_b128 v14, v[92:95] offset:0
  s_cmp_le_i32 s91, 1
  v_mad_u32_u16 v96, v29, s95, v2
  v_perm_b32 v98, v29, v29, v60
  v_perm_b32 v99, v29, v29, v61
  s_cbranch_scc1 k2_expanded
  ds_write_b128 v14, v[96:99] offset:1024
  s_cmp_le_i32 s91, 2
  v_mad_u32_u16 v92, v30, s95, v2
  v_perm_b32 v94, v30, v30, v60
  v_perm_b32 v95, v30, v30, v61
  s_cbranch_scc1 k2_expanded
  ds_write_b128 v14, v[92:95] offset:2048
  s_cmp_le_i32 s91, 3
  v_mad_u32_u16 v96, v31, s95, v2
  v_perm_b32 v98, v31, v31, v60
  v_perm_b32 v99, v31, v31, v61
  s_cbranch_scc1 k2_expanded
  ds_write_b128 v14, v[96:99] offset:3072
  s_cmp_le_i32 s91, 32
  v_mad_u32_u16 v92, v32, s95, v2
  v_perm_b32 v94, v32, v32, v60
  v_perm_b32 v95, v32, v32, v61
  s_cbranch_scc1 k2_expanded
  ds_write_b128 v14, v[92:95] offset:32768
  s_cmp_le_i32 s91, 33
  v_mad_u32_u16 v96, v33, s95, v2
  v_perm_b32 v98, v33, v33, v60
  v_perm_b32 v99, v33, v33, v61
  s_cbranch_scc1 k2_expanded
  ds_write_b128 v14, v[96:99] offset:33792
  s_cmp_le_i32 s91, 34
  v_mad_u32_u16 v92, v34, s95, v2
  v_perm_b32 v94, v34, v34, v60
  v_perm_b32 v95, v34, v34, v61
  s_cbranch_scc1 k2_expanded
  ds_write_b128 v14, v[92:95] offset:34816
  s_cmp_le_i32 s91, 35
  v_mad_u32_u16 v96, v35, s95, v2
  v_perm_b32 v98, v35, v35, v60
  v_perm_b32 v99, v35, v35, v61
  s_cbranch_scc1 k2_expanded
  ds_write_b128 v14, v[96:99] offset:35840
  v_add_u32 v14, 65536, v14
  s_cmp_le_i32 s91, 64
  v_mad_u32_u16 v92, v36, s95, v2
  v_perm_b32 v94, v36, v36, v60
  v_perm_b32 v95, v36, v36, v61
  s_cbranch_scc1 k2_expanded
  ds_write_b128 v14, v[92:95] offset:0
  s_cmp_le_i32 s91, 65
  v_mad_u32_u16 v96, v37, s95, v2
  v_perm_b32 v98, v37, v37, v60
  v_perm_b32 v99, v37, v37, v61
  s_cbranch_scc1 k2_expanded
  ds_write_b128 v14, v[96:99] offset:1024
  s_cmp_le_i32 s91, 66
  v_mad_u32_u16 v92, v38, s95, v2
  v_perm_b32 v94, v38, v38, v60
  v_perm_b32 v95, v38, v38, v61
  s_cbranch_scc1 k2_expanded
  ds_write_b128 v14, v[92:95] offset:2048
  s_cmp_le_i32 s91, 67
  v_mad_u32_u16 v96, v39, s95, v2
  v_perm_b32 v98, v39, v39, v60
  v_perm_b32 v99, v39, v39, v61
  s_cbranch_scc1 k2_expanded
  ds_write_b128 v14, v[96:99] offset:3072
k2_expanded:
  s_cmp_lg_u32 s26, 0
  s_cbranch_scc1 k2_nodup
  v_add_u32 v14, s93, v4
  ds_write_b128 v14, v[148:151] offset:4096
k2_nodup:
  s_waitcnt vmcnt(5)
  v_and_b32 v64, 0xffff, v40
  v_lshlrev_b32 v64, 9, v64
  ds_write_b32 v85, v64 offset:0
  v_lshrrev_b32 v65, 16, v40
  v_cvt_f32_u32 v65, v65
  ds_write_b32 v85, v65 offset:256
  ds_write_b64 v7, v[42:43]
  s_mov_b32 m0, s70
  s_nop 0
  s_movrels_b32 s88, s56
  s_and_b32 s64, s88, 0xff
  s_bfe_u32 s89, s88, 0x20008
  s_or_b32 s82, s82, s89
  s_andn2_b32 s88, s88, 0x3ff
  s_add_u32 s70, s88, 4096
  s_mov_b32 m0, s71
  s_nop 0
  s_movrels_b32 s88, s56
  s_and_b32 s65, s88, 0xff
  s_bfe_u32 s89, s88, 0x20008
  s_or_b32 s83, s83, s89
  s_andn2_b32 s88, s88, 0x3ff
  s_add_u32 s71, s88, 4096
  s_mov_b32 m0, s72
  s_nop 0
  s_movrels_b32 s88, s56
  s_and_b32 s66, s88, 0xff
  s_bfe_u32 s89, s88, 0x20008
  s_or_b32 s84, s84, s89
  s_andn2_b32 s88, s88, 0x3ff
  s_add_u32 s72, s88, 4096
  s_mov_b32 m0, s73
  s_nop 0
  s_movrels_b32 s88, s56
  s_and_b32 s67, s88, 0xff
  s_bfe_u32 s89, s88, 0x20008
  s_or_b32 s85, s85, s89
  s_andn2_b32 s88, s88, 0x3ff
  s_add_u32 s73, s88, 4096
  s_mov_b32 m0, s74
  s_nop 0
  s_movrels_b32 s88, s56
  s_and_b32 s68, s88, 0xff
  s_bfe_u32 s89, s88, 0x20008
  s_or_b32 s86, s86, s89
  s_andn2_b32 s88, s88, 0x3ff
  s_add_u32 s74, s88, 4096
  s_mov_b32 m0, s15
  s_add_u32 s15, s15, 1
  s_movrels_b32 s88, s70
  s_movrels_b32 s11, s64
  s_movrels_b32 s16, s76
  s_add_u32 s88, s88, 0
  s_add_u32 s11, s11, 1
  v_add_u32 v3, s88, v4
  buffer_load_dwordx4 v[124:127], v152, s[28:31], s16 offen offset:0
  buffer_load_dwordx4 v[128:131], v152, s[28:31], s16 offen offset:64
  buffer_load_dwordx4 v[132:135], v156, s[28:31], s16 offen offset:0
  buffer_load_dwordx4 v[136:139], v156, s[28:31], s16 offen offset:64
  buffer_load_dwordx4 v[140:143], v160, s[28:31], s16 offen offset:0
  buffer_load_dwordx4 v[144:147], v160, s[28:31], s16 offen offset:64
  s_cmp_lt_u32 s11, 5
  s_waitcnt lgkmcnt(0)
  s_barrier
  s_cbranch_scc1 k2_short_first
  v_add_u32 v3, 4096, v3
  s_sub_u32 s11, s11, 4
k2_primed:
  s_lshr_b32 s88, s82, 16
  v_add_u32 v7, s88, v6
  ds_read_b64 v[24:25], v7
  v_mfma_f32_32x32x8bf16_1k v[84:99], v[176:177], v[176:177], 0
  s_waitcnt vmcnt(6)
  v_smfmac_f32_32x32x32_bf16 v[84:99], v[172:175], v[164:171], v178
  v_and_b32 v14, 48, v1
  ds_read_b128 v[44:47], v14 offset:256
  ds_read_b128 v[48:51], v14 offset:320
  ds_read_b128 v[52:55], v14 offset:384
  s_mov_b32 s88, 0xbfb8aa3b
  v_lshlrev_b32 v56, 16, v11
  v_and_b32 v57, 0xffff0000, v11
  v_mul_f32 v56, s88, v56
  v_mul_f32 v57, s88, v57
  s_waitcnt lgkmcnt(0)
  v_mul_f32 v180, v44, v56
  v_mul_f32 v181, v45, v56
  v_mul_f32 v182, v46, v56
  v_mul_f32 v183, v47, v56
  v_mul_f32 v184, v44, v57
  v_mul_f32 v185, v45, v57
  v_mul_f32 v186, v46, v57
  v_mul_f32 v187, v47, v57
  v_mul_f32 v188, v48, v56
  v_mul_f32 v189, v49, v56
  v_mul_f32 v190, v50, v56
  v_mul_f32 v191, v51, v56
  v_mul_f32 v192, v48, v57
  v_mul_f32 v193, v49, v57
  v_mul_f32 v194, v50, v57
  v_mul_f32 v195, v51, v57
  v_mul_f32 v196, v52, v56
  v_mul_f32 v197, v53, v56
  v_mul_f32 v198, v54, v56
  v_mul_f32 v199, v55, v56
  v_mul_f32 v200, v52, v57
  v_mul_f32 v201, v53, v57
  v_mul_f32 v202, v54, v57
  v_mul_f32 v203, v55, v57
  v_mad_u32_u16 v13, v19, s95, v2
  s_mov_b32 s17, s77
  s_waitcnt lgkmcnt(0)
  v_mfma_f32_32x32x8bf16_1k v[28:43], v[24:25], v[150:151], v[84:99]
  buffer_load_dwordx4 v[164:167], v13, s[32:35], s17 offen offset:0
  buffer_load_dwordx4 v[168:171], v13, s[32:35], s17 offen offset:64
  ds_read_b128 v[148:151], v3 offset:0
  v_add_u32 v3, 1024, v3
  buffer_load_dword v204, v4, s[28:31], s81 offen
  buffer_load_dword v205, v4, s[28:31], s81 offen
  buffer_load_dword v206, v4, s[28:31], s81 offen
  buffer_load_dword v207, v4, s[28:31], s81 offen
  s_add_u32 s6, s8, k2_first0-k2_pcbase
  s_addc_u32 s7, s9, 0
  s_waitcnt vmcnt(12)
  v_smfmac_f32_32x32x32_bf16 v[28:43], v[172:175], v[116:123], v178
  s_lshr_b32 s90, s83, 16
  v_add_u32 v7, s90, v6
  v_lshrrev_b32 v8, 16, v18
  v_mad_u32_u16 v13, v20, s95, v2
  s_mov_b32 s17, s78
  s_add_u32 s4, s8, k2_bound0-k2_pcbase
  s_addc_u32 s5, s9, 0
  s_lshl_b32 s13, s64, 1
  s_and_b32 s14, s82, 1
  s_min_u32 s10, s11, s64
  s_sub_u32 s11, s11, s10
  s_sub_u32 s12, s64, s10
  s_cmp_eq_u32 s11, 0
  s_cselect_b64 vcc, -1, 0
  s_sub_u32 s10, s10, 1
  s_cmp_lt_u32 s26, 4
  s_setprio 2
  s_cbranch_scc1 k2_prio0
  s_setprio 3
k2_prio0:
  s_bitcmp1_b32 s82, 1
  s_nop 1
  s_cbranch_scc1 k2_rare
  s_setpc_b64 s[6:7]
.p2align 6
k2_normal0:
  v_mfma_f32_32x32x8bf16_1k v[44:59], v[24:25], v[154:155], v[84:99]
  v_exp_f32 v60, v28
  v_exp_f32 v61, v29
  v_exp_f32 v62, v30
  v_exp_f32 v63, v31
  v_exp_f32 v64, v32
  s_waitcnt vmcnt(4) lgkmcnt(0)
  v_smfmac_f32_32x32x32_bf16 v[44:59], v[172:175], v[124:131], v178
  buffer_load_dwordx4 v[116:119], v148, s[28:31], s16 offen offset:0
  buffer_load_dwordx4 v[120:123], v148, s[28:31], s16 offen offset:64
  ds_read_b128 v[152:155], v3 offset:0
  v_exp_f32 v65, v33
  v_exp_f32 v66, v34
  v_exp_f32 v67, v35
  v_pk_fma_f32 v[100:101], v[100:101], v[60:61], v[100:101]
  v_pk_fma_f32 v[102:103], v[102:103], v[62:63], v[102:103]
  v_pk_fma_f32 v[104:105], v[104:105], v[64:65], v[104:105]
  v_pk_fma_f32 v[106:107], v[106:107], v[66:67], v[106:107]
  v_pk_fma_f32 v[100:101], v[28:29], v[108:109], v[100:101]
  v_pk_fma_f32 v[102:103], v[30:31], v[110:111], v[102:103]
  v_pk_fma_f32 v[104:105], v[32:33], v[112:113], v[104:105]
  v_pk_fma_f32 v[106:107], v[34:35], v[114:115], v[106:107]
  v_exp_f32 v68, v36
  v_exp_f32 v69, v37
  v_exp_f32 v70, v38
  v_exp_f32 v71, v39
  v_exp_f32 v72, v40
  v_exp_f32 v73, v41
  v_exp_f32 v74, v42
  v_exp_f32 v75, v43
  v_pk_fma_f32 v[108:109], v[108:109], v[60:61], v[108:109]
  v_pk_fma_f32 v[110:111], v[110:111], v[62:63], v[110:111]
  v_pk_fma_f32 v[112:113], v[112:113], v[64:65], v[112:113]
  v_pk_fma_f32 v[114:115], v[114:115], v[66:67], v[114:115]
  v_pk_fma_f32 v[100:101], v[100:101], v[68:69], v[100:101]
  v_pk_fma_f32 v[102:103], v[102:103], v[70:71], v[102:103]
  v_pk_fma_f32 v[104:105], v[104:105], v[72:73], v[104:105]
  v_pk_fma_f32 v[106:107], v[106:107], v[74:75], v[106:107]
  v_pk_fma_f32 v[100:101], v[36:37], v[108:109], v[100:101]
  v_pk_fma_f32 v[102:103], v[38:39], v[110:111], v[102:103]
  v_pk_fma_f32 v[104:105], v[40:41], v[112:113], v[104:105]
  v_pk_fma_f32 v[106:107], v[42:43], v[114:115], v[106:107]
  v_pk_fma_f32 v[108:109], v[108:109], v[68:69], v[108:109]
  s_sub_u32 s10, s10, 1
  v_pk_fma_f32 v[110:111], v[110:111], v[70:71], v[110:111]
  v_pk_fma_f32 v[112:113], v[112:113], v[72:73], v[112:113]
  v_pk_fma_f32 v[114:115], v[114:115], v[74:75], v[114:115]
  s_cbranch_scc1 k2_event1
k2_normal1:
  v_mfma_f32_32x32x8bf16_1k v[28:43], v[24:25], v[158:159], v[84:99]
  v_exp_f32 v60, v44
  v_exp_f32 v61, v45
  v_exp_f32 v62, v46
  v_exp_f32 v63, v47
  v_exp_f32 v64, v48
  s_waitcnt vmcnt(4) lgkmcnt(0)
  v_smfmac_f32_32x32x32_bf16 v[28:43], v[172:175], v[132:139], v178
  buffer_load_dwordx4 v[124:127], v152, s[28:31], s16 offen offset:0
  buffer_load_dwordx4 v[128:131], v152, s[28:31], s16 offen offset:64
  ds_read_b128 v[156:159], v3 offset:1024
  v_exp_f32 v65, v49
  v_exp_f32 v66, v50
  v_exp_f32 v67, v51
  v_pk_fma_f32 v[100:101], v[100:101], v[60:61], v[100:101]
  v_pk_fma_f32 v[102:103], v[102:103], v[62:63], v[102:103]
  v_pk_fma_f32 v[104:105], v[104:105], v[64:65], v[104:105]
  v_pk_fma_f32 v[106:107], v[106:107], v[66:67], v[106:107]
  v_pk_fma_f32 v[100:101], v[44:45], v[108:109], v[100:101]
  v_pk_fma_f32 v[102:103], v[46:47], v[110:111], v[102:103]
  v_pk_fma_f32 v[104:105], v[48:49], v[112:113], v[104:105]
  v_pk_fma_f32 v[106:107], v[50:51], v[114:115], v[106:107]
  v_exp_f32 v68, v52
  v_exp_f32 v69, v53
  v_exp_f32 v70, v54
  v_exp_f32 v71, v55
  v_exp_f32 v72, v56
  v_exp_f32 v73, v57
  v_exp_f32 v74, v58
  v_exp_f32 v75, v59
  v_pk_fma_f32 v[108:109], v[108:109], v[60:61], v[108:109]
  v_pk_fma_f32 v[110:111], v[110:111], v[62:63], v[110:111]
  v_pk_fma_f32 v[112:113], v[112:113], v[64:65], v[112:113]
  v_pk_fma_f32 v[114:115], v[114:115], v[66:67], v[114:115]
  v_pk_fma_f32 v[100:101], v[100:101], v[68:69], v[100:101]
  v_pk_fma_f32 v[102:103], v[102:103], v[70:71], v[102:103]
  v_pk_fma_f32 v[104:105], v[104:105], v[72:73], v[104:105]
  v_pk_fma_f32 v[106:107], v[106:107], v[74:75], v[106:107]
  v_pk_fma_f32 v[100:101], v[52:53], v[108:109], v[100:101]
  v_pk_fma_f32 v[102:103], v[54:55], v[110:111], v[102:103]
  v_pk_fma_f32 v[104:105], v[56:57], v[112:113], v[104:105]
  v_pk_fma_f32 v[106:107], v[58:59], v[114:115], v[106:107]
  v_pk_fma_f32 v[108:109], v[108:109], v[68:69], v[108:109]
  s_sub_u32 s10, s10, 1
  v_pk_fma_f32 v[110:111], v[110:111], v[70:71], v[110:111]
  v_pk_fma_f32 v[112:113], v[112:113], v[72:73], v[112:113]
  v_pk_fma_f32 v[114:115], v[114:115], v[74:75], v[114:115]
  s_cbranch_scc1 k2_event2
k2_normal2:
  v_mfma_f32_32x32x8bf16_1k v[44:59], v[24:25], v[162:163], v[84:99]
  v_exp_f32 v60, v28
  v_exp_f32 v61, v29
  v_exp_f32 v62, v30
  v_exp_f32 v63, v31
  v_exp_f32 v64, v32
  s_waitcnt vmcnt(4) lgkmcnt(0)
  v_smfmac_f32_32x32x32_bf16 v[44:59], v[172:175], v[140:147], v178
  buffer_load_dwordx4 v[132:135], v156, s[28:31], s16 offen offset:0
  buffer_load_dwordx4 v[136:139], v156, s[28:31], s16 offen offset:64
  ds_read_b128 v[160:163], v3 offset:2048
  v_exp_f32 v65, v33
  v_exp_f32 v66, v34
  v_exp_f32 v67, v35
  v_pk_fma_f32 v[100:101], v[100:101], v[60:61], v[100:101]
  v_pk_fma_f32 v[102:103], v[102:103], v[62:63], v[102:103]
  v_pk_fma_f32 v[104:105], v[104:105], v[64:65], v[104:105]
  v_pk_fma_f32 v[106:107], v[106:107], v[66:67], v[106:107]
  v_pk_fma_f32 v[100:101], v[28:29], v[108:109], v[100:101]
  v_pk_fma_f32 v[102:103], v[30:31], v[110:111], v[102:103]
  v_pk_fma_f32 v[104:105], v[32:33], v[112:113], v[104:105]
  v_pk_fma_f32 v[106:107], v[34:35], v[114:115], v[106:107]
  v_exp_f32 v68, v36
  v_exp_f32 v69, v37
  v_exp_f32 v70, v38
  v_exp_f32 v71, v39
  v_exp_f32 v72, v40
  v_exp_f32 v73, v41
  v_exp_f32 v74, v42
  v_exp_f32 v75, v43
  v_pk_fma_f32 v[108:109], v[108:109], v[60:61], v[108:109]
  v_pk_fma_f32 v[110:111], v[110:111], v[62:63], v[110:111]
  v_pk_fma_f32 v[112:113], v[112:113], v[64:65], v[112:113]
  v_pk_fma_f32 v[114:115], v[114:115], v[66:67], v[114:115]
  v_pk_fma_f32 v[100:101], v[100:101], v[68:69], v[100:101]
  v_pk_fma_f32 v[102:103], v[102:103], v[70:71], v[102:103]
  v_pk_fma_f32 v[104:105], v[104:105], v[72:73], v[104:105]
  v_pk_fma_f32 v[106:107], v[106:107], v[74:75], v[106:107]
  v_pk_fma_f32 v[100:101], v[36:37], v[108:109], v[100:101]
  v_pk_fma_f32 v[102:103], v[38:39], v[110:111], v[102:103]
  v_pk_fma_f32 v[104:105], v[40:41], v[112:113], v[104:105]
  v_pk_fma_f32 v[106:107], v[42:43], v[114:115], v[106:107]
  v_pk_fma_f32 v[108:109], v[108:109], v[68:69], v[108:109]
  s_sub_u32 s10, s10, 1
  v_pk_fma_f32 v[110:111], v[110:111], v[70:71], v[110:111]
  v_pk_fma_f32 v[112:113], v[112:113], v[72:73], v[112:113]
  v_pk_fma_f32 v[114:115], v[114:115], v[74:75], v[114:115]
  s_cbranch_scc1 k2_event3
k2_normal3:
  v_mfma_f32_32x32x8bf16_1k v[28:43], v[24:25], v[150:151], v[84:99]
  v_exp_f32 v60, v44
  v_exp_f32 v61, v45
  v_exp_f32 v62, v46
  v_exp_f32 v63, v47
  v_exp_f32 v64, v48
  s_waitcnt vmcnt(4) lgkmcnt(0)
  v_smfmac_f32_32x32x32_bf16 v[28:43], v[172:175], v[116:123], v178
  buffer_load_dwordx4 v[140:143], v160, s[28:31], s16 offen offset:0
  buffer_load_dwordx4 v[144:147], v160, s[28:31], s16 offen offset:64
  ds_read_b128 v[148:151], v3 offset:3072
  v_exp_f32 v65, v49
  v_exp_f32 v66, v50
  v_exp_f32 v67, v51
  v_pk_fma_f32 v[100:101], v[100:101], v[60:61], v[100:101]
  v_pk_fma_f32 v[102:103], v[102:103], v[62:63], v[102:103]
  v_pk_fma_f32 v[104:105], v[104:105], v[64:65], v[104:105]
  v_pk_fma_f32 v[106:107], v[106:107], v[66:67], v[106:107]
  v_pk_fma_f32 v[100:101], v[44:45], v[108:109], v[100:101]
  v_pk_fma_f32 v[102:103], v[46:47], v[110:111], v[102:103]
  v_pk_fma_f32 v[104:105], v[48:49], v[112:113], v[104:105]
  v_pk_fma_f32 v[106:107], v[50:51], v[114:115], v[106:107]
  v_add_u32 v3, 4096, v3
  v_exp_f32 v68, v52
  v_exp_f32 v69, v53
  v_exp_f32 v70, v54
  v_exp_f32 v71, v55
  v_exp_f32 v72, v56
  v_exp_f32 v73, v57
  v_exp_f32 v74, v58
  v_exp_f32 v75, v59
  v_pk_fma_f32 v[108:109], v[108:109], v[60:61], v[108:109]
  v_pk_fma_f32 v[110:111], v[110:111], v[62:63], v[110:111]
  v_pk_fma_f32 v[112:113], v[112:113], v[64:65], v[112:113]
  v_pk_fma_f32 v[114:115], v[114:115], v[66:67], v[114:115]
  v_pk_fma_f32 v[100:101], v[100:101], v[68:69], v[100:101]
  v_pk_fma_f32 v[102:103], v[102:103], v[70:71], v[102:103]
  v_pk_fma_f32 v[104:105], v[104:105], v[72:73], v[104:105]
  v_pk_fma_f32 v[106:107], v[106:107], v[74:75], v[106:107]
  v_pk_fma_f32 v[100:101], v[52:53], v[108:109], v[100:101]
  v_pk_fma_f32 v[102:103], v[54:55], v[110:111], v[102:103]
  v_pk_fma_f32 v[104:105], v[56:57], v[112:113], v[104:105]
  v_pk_fma_f32 v[106:107], v[58:59], v[114:115], v[106:107]
  v_pk_fma_f32 v[108:109], v[108:109], v[68:69], v[108:109]
  s_sub_u32 s10, s10, 1
  v_pk_fma_f32 v[110:111], v[110:111], v[70:71], v[110:111]
  v_pk_fma_f32 v[112:113], v[112:113], v[72:73], v[112:113]
  v_pk_fma_f32 v[114:115], v[114:115], v[74:75], v[114:115]
  s_cbranch_scc0 k2_normal0
k2_event0:
  s_cbranch_vccnz k2_switch0
k2_last0:
  v_mfma_f32_32x32x8bf16_1k v[84:99], v[176:177], v[176:177], 0
  ds_read_b64 v[24:25], v7
  ds_read_b32 v16, v15
  v_exp_f32 v60, v28
  v_exp_f32 v61, v29
  v_exp_f32 v62, v30
  v_exp_f32 v63, v31
  s_waitcnt vmcnt(4) lgkmcnt(2)
  v_smfmac_f32_32x32x32_bf16 v[84:99], v[172:175], v[164:171], v178
  buffer_load_dwordx4 v[116:119], v148, s[28:31], s16 offen offset:0
  buffer_load_dwordx4 v[120:123], v148, s[28:31], s16 offen offset:64
  buffer_load_dwordx4 v[164:167], v13, s[32:35], s17 offen offset:0
  buffer_load_dwordx4 v[168:171], v13, s[32:35], s17 offen offset:64
  s_cmp_lg_u32 s14, 0
  v_exp_f32 v64, v32
  v_exp_f32 v65, v33
  v_exp_f32 v66, v34
  v_exp_f32 v67, v35
  s_cbranch_scc1 k2_lastodd0
  s_waitcnt lgkmcnt(0)
  v_mfma_f32_32x32x8bf16_1k v[44:59], v[24:25], v[154:155], v[84:99]
  ds_read_b128 v[152:155], v3 offset:0
  v_exp_f32 v68, v36
  v_exp_f32 v69, v37
  v_exp_f32 v70, v38
  v_exp_f32 v71, v39
  v_exp_f32 v72, v40
  v_cmpx_lt_u32 vcc, s13, v8
  v_pk_fma_f32 v[100:101], v[100:101], v[60:61], v[100:101]
  v_pk_fma_f32 v[102:103], v[102:103], v[62:63], v[102:103]
  v_pk_fma_f32 v[104:105], v[104:105], v[64:65], v[104:105]
  v_pk_fma_f32 v[106:107], v[106:107], v[66:67], v[106:107]
  s_add_u32 s13, s13, 1
  v_pk_fma_f32 v[100:101], v[28:29], v[108:109], v[100:101]
  v_pk_fma_f32 v[102:103], v[30:31], v[110:111], v[102:103]
  v_pk_fma_f32 v[104:105], v[32:33], v[112:113], v[104:105]
  v_pk_fma_f32 v[106:107], v[34:35], v[114:115], v[106:107]
  v_pk_fma_f32 v[108:109], v[108:109], v[60:61], v[108:109]
  v_pk_fma_f32 v[110:111], v[110:111], v[62:63], v[110:111]
  v_pk_fma_f32 v[112:113], v[112:113], v[64:65], v[112:113]
  v_pk_fma_f32 v[114:115], v[114:115], v[66:67], v[114:115]
  v_exp_f32 v73, v41
  v_exp_f32 v74, v42
  v_exp_f32 v75, v43
  s_add_u32 s6, s8, k2_first1-k2_pcbase
  s_addc_u32 s7, s9, 0
  v_cmpx_lt_u32 vcc, s13, v8
  v_pk_fma_f32 v[100:101], v[100:101], v[68:69], v[100:101]
  v_pk_fma_f32 v[102:103], v[102:103], v[70:71], v[102:103]
  v_pk_fma_f32 v[104:105], v[104:105], v[72:73], v[104:105]
  v_pk_fma_f32 v[106:107], v[106:107], v[74:75], v[106:107]
  s_sub_u32 s11, s11, 1
  v_pk_fma_f32 v[100:101], v[36:37], v[108:109], v[100:101]
  v_pk_fma_f32 v[102:103], v[38:39], v[110:111], v[102:103]
  v_pk_fma_f32 v[104:105], v[40:41], v[112:113], v[104:105]
  v_pk_fma_f32 v[106:107], v[42:43], v[114:115], v[106:107]
  s_cmp_eq_u32 s11, 0
  v_pk_fma_f32 v[108:109], v[108:109], v[68:69], v[108:109]
  v_pk_fma_f32 v[110:111], v[110:111], v[70:71], v[110:111]
  v_pk_fma_f32 v[112:113], v[112:113], v[72:73], v[112:113]
  v_pk_fma_f32 v[114:115], v[114:115], v[74:75], v[114:115]
  s_mov_b64 exec, -1
  v_smfmac_f32_32x32x32_bf16 v[44:59], v[172:175], v[124:131], v178
  ds_read_b128 v[60:63], v240 offset:0
  ds_read_b128 v[64:67], v240 offset:16640
  ds_read_b128 v[68:71], v240 offset:64
  ds_read_b128 v[72:75], v240 offset:16704
  ds_read2_b32 v[236:237], v241 offset0:0 offset1:2
  ds_read2_b32 v[238:239], v241 offset0:4 offset1:6
  v_rcp_f32 v76, v108
  v_rcp_f32 v77, v109
  v_rcp_f32 v78, v110
  v_rcp_f32 v79, v111
  v_rcp_f32 v80, v112
  v_rcp_f32 v81, v113
  v_rcp_f32 v82, v114
  v_rcp_f32 v83, v115
  s_cbranch_scc1 k2_lswitch0
  s_setpc_b64 s[4:5]
k2_lastodd0:
  v_cmpx_lt_u32 vcc, s13, v8
  v_pk_fma_f32 v[100:101], v[100:101], v[60:61], v[100:101]
  v_pk_fma_f32 v[102:103], v[102:103], v[62:63], v[102:103]
  v_pk_fma_f32 v[104:105], v[104:105], v[64:65], v[104:105]
  v_pk_fma_f32 v[106:107], v[106:107], v[66:67], v[106:107]
  s_add_u32 s6, s8, k2_first1-k2_pcbase
  s_addc_u32 s7, s9, 0
  v_pk_fma_f32 v[100:101], v[28:29], v[108:109], v[100:101]
  v_pk_fma_f32 v[102:103], v[30:31], v[110:111], v[102:103]
  v_pk_fma_f32 v[104:105], v[32:33], v[112:113], v[104:105]
  v_pk_fma_f32 v[106:107], v[34:35], v[114:115], v[106:107]
  s_sub_u32 s11, s11, 1
  s_cmp_eq_u32 s11, 0
  v_pk_fma_f32 v[108:109], v[108:109], v[60:61], v[108:109]
  v_pk_fma_f32 v[110:111], v[110:111], v[62:63], v[110:111]
  v_pk_fma_f32 v[112:113], v[112:113], v[64:65], v[112:113]
  v_pk_fma_f32 v[114:115], v[114:115], v[66:67], v[114:115]
  s_mov_b64 exec, -1
  s_waitcnt lgkmcnt(0)
  v_mfma_f32_32x32x8bf16_1k v[44:59], v[24:25], v[154:155], v[84:99]
  ds_read_b128 v[152:155], v3 offset:0
  v_rcp_f32 v76, v108
  v_rcp_f32 v77, v109
  v_rcp_f32 v78, v110
  v_rcp_f32 v79, v111
  v_smfmac_f32_32x32x32_bf16 v[44:59], v[172:175], v[124:131], v178
  ds_read_b128 v[60:63], v240 offset:0
  ds_read_b128 v[64:67], v240 offset:16640
  ds_read_b128 v[68:71], v240 offset:64
  ds_read_b128 v[72:75], v240 offset:16704
  ds_read2_b32 v[236:237], v241 offset0:0 offset1:2
  ds_read2_b32 v[238:239], v241 offset0:4 offset1:6
  v_rcp_f32 v80, v112
  v_rcp_f32 v81, v113
  v_rcp_f32 v82, v114
  v_rcp_f32 v83, v115
  s_cbranch_scc1 k2_lswitch0
  s_setpc_b64 s[4:5]
k2_event1:
  s_cbranch_vccnz k2_switch1
k2_last1:
  v_mfma_f32_32x32x8bf16_1k v[84:99], v[176:177], v[176:177], 0
  ds_read_b64 v[24:25], v7
  ds_read_b32 v16, v15
  v_exp_f32 v60, v44
  v_exp_f32 v61, v45
  v_exp_f32 v62, v46
  v_exp_f32 v63, v47
  s_waitcnt vmcnt(4) lgkmcnt(2)
  v_smfmac_f32_32x32x32_bf16 v[84:99], v[172:175], v[164:171], v178
  buffer_load_dwordx4 v[124:127], v152, s[28:31], s16 offen offset:0
  buffer_load_dwordx4 v[128:131], v152, s[28:31], s16 offen offset:64
  buffer_load_dwordx4 v[164:167], v13, s[32:35], s17 offen offset:0
  buffer_load_dwordx4 v[168:171], v13, s[32:35], s17 offen offset:64
  s_cmp_lg_u32 s14, 0
  v_exp_f32 v64, v48
  v_exp_f32 v65, v49
  v_exp_f32 v66, v50
  v_exp_f32 v67, v51
  s_cbranch_scc1 k2_lastodd1
  s_waitcnt lgkmcnt(0)
  v_mfma_f32_32x32x8bf16_1k v[28:43], v[24:25], v[158:159], v[84:99]
  ds_read_b128 v[156:159], v3 offset:1024
  v_exp_f32 v68, v52
  v_exp_f32 v69, v53
  v_exp_f32 v70, v54
  v_exp_f32 v71, v55
  v_exp_f32 v72, v56
  v_cmpx_lt_u32 vcc, s13, v8
  v_pk_fma_f32 v[100:101], v[100:101], v[60:61], v[100:101]
  v_pk_fma_f32 v[102:103], v[102:103], v[62:63], v[102:103]
  v_pk_fma_f32 v[104:105], v[104:105], v[64:65], v[104:105]
  v_pk_fma_f32 v[106:107], v[106:107], v[66:67], v[106:107]
  s_add_u32 s13, s13, 1
  v_pk_fma_f32 v[100:101], v[44:45], v[108:109], v[100:101]
  v_pk_fma_f32 v[102:103], v[46:47], v[110:111], v[102:103]
  v_pk_fma_f32 v[104:105], v[48:49], v[112:113], v[104:105]
  v_pk_fma_f32 v[106:107], v[50:51], v[114:115], v[106:107]
  v_pk_fma_f32 v[108:109], v[108:109], v[60:61], v[108:109]
  v_pk_fma_f32 v[110:111], v[110:111], v[62:63], v[110:111]
  v_pk_fma_f32 v[112:113], v[112:113], v[64:65], v[112:113]
  v_pk_fma_f32 v[114:115], v[114:115], v[66:67], v[114:115]
  v_exp_f32 v73, v57
  v_exp_f32 v74, v58
  v_exp_f32 v75, v59
  s_add_u32 s6, s8, k2_first2-k2_pcbase
  s_addc_u32 s7, s9, 0
  v_cmpx_lt_u32 vcc, s13, v8
  v_pk_fma_f32 v[100:101], v[100:101], v[68:69], v[100:101]
  v_pk_fma_f32 v[102:103], v[102:103], v[70:71], v[102:103]
  v_pk_fma_f32 v[104:105], v[104:105], v[72:73], v[104:105]
  v_pk_fma_f32 v[106:107], v[106:107], v[74:75], v[106:107]
  s_sub_u32 s11, s11, 1
  v_pk_fma_f32 v[100:101], v[52:53], v[108:109], v[100:101]
  v_pk_fma_f32 v[102:103], v[54:55], v[110:111], v[102:103]
  v_pk_fma_f32 v[104:105], v[56:57], v[112:113], v[104:105]
  v_pk_fma_f32 v[106:107], v[58:59], v[114:115], v[106:107]
  s_cmp_eq_u32 s11, 0
  v_pk_fma_f32 v[108:109], v[108:109], v[68:69], v[108:109]
  v_pk_fma_f32 v[110:111], v[110:111], v[70:71], v[110:111]
  v_pk_fma_f32 v[112:113], v[112:113], v[72:73], v[112:113]
  v_pk_fma_f32 v[114:115], v[114:115], v[74:75], v[114:115]
  s_mov_b64 exec, -1
  v_smfmac_f32_32x32x32_bf16 v[28:43], v[172:175], v[132:139], v178
  ds_read_b128 v[60:63], v240 offset:0
  ds_read_b128 v[64:67], v240 offset:16640
  ds_read_b128 v[68:71], v240 offset:64
  ds_read_b128 v[72:75], v240 offset:16704
  ds_read2_b32 v[236:237], v241 offset0:0 offset1:2
  ds_read2_b32 v[238:239], v241 offset0:4 offset1:6
  v_rcp_f32 v76, v108
  v_rcp_f32 v77, v109
  v_rcp_f32 v78, v110
  v_rcp_f32 v79, v111
  v_rcp_f32 v80, v112
  v_rcp_f32 v81, v113
  v_rcp_f32 v82, v114
  v_rcp_f32 v83, v115
  s_cbranch_scc1 k2_lswitch1
  s_setpc_b64 s[4:5]
k2_lastodd1:
  v_cmpx_lt_u32 vcc, s13, v8
  v_pk_fma_f32 v[100:101], v[100:101], v[60:61], v[100:101]
  v_pk_fma_f32 v[102:103], v[102:103], v[62:63], v[102:103]
  v_pk_fma_f32 v[104:105], v[104:105], v[64:65], v[104:105]
  v_pk_fma_f32 v[106:107], v[106:107], v[66:67], v[106:107]
  s_add_u32 s6, s8, k2_first2-k2_pcbase
  s_addc_u32 s7, s9, 0
  v_pk_fma_f32 v[100:101], v[44:45], v[108:109], v[100:101]
  v_pk_fma_f32 v[102:103], v[46:47], v[110:111], v[102:103]
  v_pk_fma_f32 v[104:105], v[48:49], v[112:113], v[104:105]
  v_pk_fma_f32 v[106:107], v[50:51], v[114:115], v[106:107]
  s_sub_u32 s11, s11, 1
  s_cmp_eq_u32 s11, 0
  v_pk_fma_f32 v[108:109], v[108:109], v[60:61], v[108:109]
  v_pk_fma_f32 v[110:111], v[110:111], v[62:63], v[110:111]
  v_pk_fma_f32 v[112:113], v[112:113], v[64:65], v[112:113]
  v_pk_fma_f32 v[114:115], v[114:115], v[66:67], v[114:115]
  s_mov_b64 exec, -1
  s_waitcnt lgkmcnt(0)
  v_mfma_f32_32x32x8bf16_1k v[28:43], v[24:25], v[158:159], v[84:99]
  ds_read_b128 v[156:159], v3 offset:1024
  v_rcp_f32 v76, v108
  v_rcp_f32 v77, v109
  v_rcp_f32 v78, v110
  v_rcp_f32 v79, v111
  v_smfmac_f32_32x32x32_bf16 v[28:43], v[172:175], v[132:139], v178
  ds_read_b128 v[60:63], v240 offset:0
  ds_read_b128 v[64:67], v240 offset:16640
  ds_read_b128 v[68:71], v240 offset:64
  ds_read_b128 v[72:75], v240 offset:16704
  ds_read2_b32 v[236:237], v241 offset0:0 offset1:2
  ds_read2_b32 v[238:239], v241 offset0:4 offset1:6
  v_rcp_f32 v80, v112
  v_rcp_f32 v81, v113
  v_rcp_f32 v82, v114
  v_rcp_f32 v83, v115
  s_cbranch_scc1 k2_lswitch1
  s_setpc_b64 s[4:5]
k2_event2:
  s_cbranch_vccnz k2_switch2
k2_last2:
  v_mfma_f32_32x32x8bf16_1k v[84:99], v[176:177], v[176:177], 0
  ds_read_b64 v[24:25], v7
  ds_read_b32 v16, v15
  v_exp_f32 v60, v28
  v_exp_f32 v61, v29
  v_exp_f32 v62, v30
  v_exp_f32 v63, v31
  s_waitcnt vmcnt(4) lgkmcnt(2)
  v_smfmac_f32_32x32x32_bf16 v[84:99], v[172:175], v[164:171], v178
  buffer_load_dwordx4 v[132:135], v156, s[28:31], s16 offen offset:0
  buffer_load_dwordx4 v[136:139], v156, s[28:31], s16 offen offset:64
  buffer_load_dwordx4 v[164:167], v13, s[32:35], s17 offen offset:0
  buffer_load_dwordx4 v[168:171], v13, s[32:35], s17 offen offset:64
  s_cmp_lg_u32 s14, 0
  v_exp_f32 v64, v32
  v_exp_f32 v65, v33
  v_exp_f32 v66, v34
  v_exp_f32 v67, v35
  s_cbranch_scc1 k2_lastodd2
  s_waitcnt lgkmcnt(0)
  v_mfma_f32_32x32x8bf16_1k v[44:59], v[24:25], v[162:163], v[84:99]
  ds_read_b128 v[160:163], v3 offset:2048
  v_exp_f32 v68, v36
  v_exp_f32 v69, v37
  v_exp_f32 v70, v38
  v_exp_f32 v71, v39
  v_exp_f32 v72, v40
  v_cmpx_lt_u32 vcc, s13, v8
  v_pk_fma_f32 v[100:101], v[100:101], v[60:61], v[100:101]
  v_pk_fma_f32 v[102:103], v[102:103], v[62:63], v[102:103]
  v_pk_fma_f32 v[104:105], v[104:105], v[64:65], v[104:105]
  v_pk_fma_f32 v[106:107], v[106:107], v[66:67], v[106:107]
  s_add_u32 s13, s13, 1
  v_pk_fma_f32 v[100:101], v[28:29], v[108:109], v[100:101]
  v_pk_fma_f32 v[102:103], v[30:31], v[110:111], v[102:103]
  v_pk_fma_f32 v[104:105], v[32:33], v[112:113], v[104:105]
  v_pk_fma_f32 v[106:107], v[34:35], v[114:115], v[106:107]
  v_pk_fma_f32 v[108:109], v[108:109], v[60:61], v[108:109]
  v_pk_fma_f32 v[110:111], v[110:111], v[62:63], v[110:111]
  v_pk_fma_f32 v[112:113], v[112:113], v[64:65], v[112:113]
  v_pk_fma_f32 v[114:115], v[114:115], v[66:67], v[114:115]
  v_exp_f32 v73, v41
  v_exp_f32 v74, v42
  v_exp_f32 v75, v43
  s_add_u32 s6, s8, k2_first3-k2_pcbase
  s_addc_u32 s7, s9, 0
  v_cmpx_lt_u32 vcc, s13, v8
  v_pk_fma_f32 v[100:101], v[100:101], v[68:69], v[100:101]
  v_pk_fma_f32 v[102:103], v[102:103], v[70:71], v[102:103]
  v_pk_fma_f32 v[104:105], v[104:105], v[72:73], v[104:105]
  v_pk_fma_f32 v[106:107], v[106:107], v[74:75], v[106:107]
  s_sub_u32 s11, s11, 1
  v_pk_fma_f32 v[100:101], v[36:37], v[108:109], v[100:101]
  v_pk_fma_f32 v[102:103], v[38:39], v[110:111], v[102:103]
  v_pk_fma_f32 v[104:105], v[40:41], v[112:113], v[104:105]
  v_pk_fma_f32 v[106:107], v[42:43], v[114:115], v[106:107]
  s_cmp_eq_u32 s11, 0
  v_pk_fma_f32 v[108:109], v[108:109], v[68:69], v[108:109]
  v_pk_fma_f32 v[110:111], v[110:111], v[70:71], v[110:111]
  v_pk_fma_f32 v[112:113], v[112:113], v[72:73], v[112:113]
  v_pk_fma_f32 v[114:115], v[114:115], v[74:75], v[114:115]
  s_mov_b64 exec, -1
  v_smfmac_f32_32x32x32_bf16 v[44:59], v[172:175], v[140:147], v178
  ds_read_b128 v[60:63], v240 offset:0
  ds_read_b128 v[64:67], v240 offset:16640
  ds_read_b128 v[68:71], v240 offset:64
  ds_read_b128 v[72:75], v240 offset:16704
  ds_read2_b32 v[236:237], v241 offset0:0 offset1:2
  ds_read2_b32 v[238:239], v241 offset0:4 offset1:6
  v_rcp_f32 v76, v108
  v_rcp_f32 v77, v109
  v_rcp_f32 v78, v110
  v_rcp_f32 v79, v111
  v_rcp_f32 v80, v112
  v_rcp_f32 v81, v113
  v_rcp_f32 v82, v114
  v_rcp_f32 v83, v115
  s_cbranch_scc1 k2_lswitch2
  s_setpc_b64 s[4:5]
k2_lastodd2:
  v_cmpx_lt_u32 vcc, s13, v8
  v_pk_fma_f32 v[100:101], v[100:101], v[60:61], v[100:101]
  v_pk_fma_f32 v[102:103], v[102:103], v[62:63], v[102:103]
  v_pk_fma_f32 v[104:105], v[104:105], v[64:65], v[104:105]
  v_pk_fma_f32 v[106:107], v[106:107], v[66:67], v[106:107]
  s_add_u32 s6, s8, k2_first3-k2_pcbase
  s_addc_u32 s7, s9, 0
  v_pk_fma_f32 v[100:101], v[28:29], v[108:109], v[100:101]
  v_pk_fma_f32 v[102:103], v[30:31], v[110:111], v[102:103]
  v_pk_fma_f32 v[104:105], v[32:33], v[112:113], v[104:105]
  v_pk_fma_f32 v[106:107], v[34:35], v[114:115], v[106:107]
  s_sub_u32 s11, s11, 1
  s_cmp_eq_u32 s11, 0
  v_pk_fma_f32 v[108:109], v[108:109], v[60:61], v[108:109]
  v_pk_fma_f32 v[110:111], v[110:111], v[62:63], v[110:111]
  v_pk_fma_f32 v[112:113], v[112:113], v[64:65], v[112:113]
  v_pk_fma_f32 v[114:115], v[114:115], v[66:67], v[114:115]
  s_mov_b64 exec, -1
  s_waitcnt lgkmcnt(0)
  v_mfma_f32_32x32x8bf16_1k v[44:59], v[24:25], v[162:163], v[84:99]
  ds_read_b128 v[160:163], v3 offset:2048
  v_rcp_f32 v76, v108
  v_rcp_f32 v77, v109
  v_rcp_f32 v78, v110
  v_rcp_f32 v79, v111
  v_smfmac_f32_32x32x32_bf16 v[44:59], v[172:175], v[140:147], v178
  ds_read_b128 v[60:63], v240 offset:0
  ds_read_b128 v[64:67], v240 offset:16640
  ds_read_b128 v[68:71], v240 offset:64
  ds_read_b128 v[72:75], v240 offset:16704
  ds_read2_b32 v[236:237], v241 offset0:0 offset1:2
  ds_read2_b32 v[238:239], v241 offset0:4 offset1:6
  v_rcp_f32 v80, v112
  v_rcp_f32 v81, v113
  v_rcp_f32 v82, v114
  v_rcp_f32 v83, v115
  s_cbranch_scc1 k2_lswitch2
  s_setpc_b64 s[4:5]
k2_event3:
  s_cbranch_vccnz k2_switch3
k2_last3:
  v_mfma_f32_32x32x8bf16_1k v[84:99], v[176:177], v[176:177], 0
  ds_read_b64 v[24:25], v7
  ds_read_b32 v16, v15
  v_exp_f32 v60, v44
  v_exp_f32 v61, v45
  v_exp_f32 v62, v46
  v_exp_f32 v63, v47
  s_waitcnt vmcnt(4) lgkmcnt(2)
  v_smfmac_f32_32x32x32_bf16 v[84:99], v[172:175], v[164:171], v178
  buffer_load_dwordx4 v[140:143], v160, s[28:31], s16 offen offset:0
  buffer_load_dwordx4 v[144:147], v160, s[28:31], s16 offen offset:64
  buffer_load_dwordx4 v[164:167], v13, s[32:35], s17 offen offset:0
  buffer_load_dwordx4 v[168:171], v13, s[32:35], s17 offen offset:64
  s_cmp_lg_u32 s14, 0
  v_exp_f32 v64, v48
  v_exp_f32 v65, v49
  v_exp_f32 v66, v50
  v_exp_f32 v67, v51
  s_cbranch_scc1 k2_lastodd3
  s_waitcnt lgkmcnt(0)
  v_mfma_f32_32x32x8bf16_1k v[28:43], v[24:25], v[150:151], v[84:99]
  ds_read_b128 v[148:151], v3 offset:3072
  v_exp_f32 v68, v52
  v_exp_f32 v69, v53
  v_exp_f32 v70, v54
  v_exp_f32 v71, v55
  v_exp_f32 v72, v56
  v_add_u32 v3, 4096, v3
  v_cmpx_lt_u32 vcc, s13, v8
  v_pk_fma_f32 v[100:101], v[100:101], v[60:61], v[100:101]
  v_pk_fma_f32 v[102:103], v[102:103], v[62:63], v[102:103]
  v_pk_fma_f32 v[104:105], v[104:105], v[64:65], v[104:105]
  v_pk_fma_f32 v[106:107], v[106:107], v[66:67], v[106:107]
  s_add_u32 s13, s13, 1
  v_pk_fma_f32 v[100:101], v[44:45], v[108:109], v[100:101]
  v_pk_fma_f32 v[102:103], v[46:47], v[110:111], v[102:103]
  v_pk_fma_f32 v[104:105], v[48:49], v[112:113], v[104:105]
  v_pk_fma_f32 v[106:107], v[50:51], v[114:115], v[106:107]
  v_pk_fma_f32 v[108:109], v[108:109], v[60:61], v[108:109]
  v_pk_fma_f32 v[110:111], v[110:111], v[62:63], v[110:111]
  v_pk_fma_f32 v[112:113], v[112:113], v[64:65], v[112:113]
  v_pk_fma_f32 v[114:115], v[114:115], v[66:67], v[114:115]
  v_exp_f32 v73, v57
  v_exp_f32 v74, v58
  v_exp_f32 v75, v59
  s_add_u32 s6, s8, k2_first0-k2_pcbase
  s_addc_u32 s7, s9, 0
  v_cmpx_lt_u32 vcc, s13, v8
  v_pk_fma_f32 v[100:101], v[100:101], v[68:69], v[100:101]
  v_pk_fma_f32 v[102:103], v[102:103], v[70:71], v[102:103]
  v_pk_fma_f32 v[104:105], v[104:105], v[72:73], v[104:105]
  v_pk_fma_f32 v[106:107], v[106:107], v[74:75], v[106:107]
  s_sub_u32 s11, s11, 1
  v_pk_fma_f32 v[100:101], v[52:53], v[108:109], v[100:101]
  v_pk_fma_f32 v[102:103], v[54:55], v[110:111], v[102:103]
  v_pk_fma_f32 v[104:105], v[56:57], v[112:113], v[104:105]
  v_pk_fma_f32 v[106:107], v[58:59], v[114:115], v[106:107]
  s_cmp_eq_u32 s11, 0
  v_pk_fma_f32 v[108:109], v[108:109], v[68:69], v[108:109]
  v_pk_fma_f32 v[110:111], v[110:111], v[70:71], v[110:111]
  v_pk_fma_f32 v[112:113], v[112:113], v[72:73], v[112:113]
  v_pk_fma_f32 v[114:115], v[114:115], v[74:75], v[114:115]
  s_mov_b64 exec, -1
  v_smfmac_f32_32x32x32_bf16 v[28:43], v[172:175], v[116:123], v178
  ds_read_b128 v[60:63], v240 offset:0
  ds_read_b128 v[64:67], v240 offset:16640
  ds_read_b128 v[68:71], v240 offset:64
  ds_read_b128 v[72:75], v240 offset:16704
  ds_read2_b32 v[236:237], v241 offset0:0 offset1:2
  ds_read2_b32 v[238:239], v241 offset0:4 offset1:6
  v_rcp_f32 v76, v108
  v_rcp_f32 v77, v109
  v_rcp_f32 v78, v110
  v_rcp_f32 v79, v111
  v_rcp_f32 v80, v112
  v_rcp_f32 v81, v113
  v_rcp_f32 v82, v114
  v_rcp_f32 v83, v115
  s_cbranch_scc1 k2_lswitch3
  s_setpc_b64 s[4:5]
k2_lastodd3:
  v_cmpx_lt_u32 vcc, s13, v8
  v_pk_fma_f32 v[100:101], v[100:101], v[60:61], v[100:101]
  v_pk_fma_f32 v[102:103], v[102:103], v[62:63], v[102:103]
  v_pk_fma_f32 v[104:105], v[104:105], v[64:65], v[104:105]
  v_pk_fma_f32 v[106:107], v[106:107], v[66:67], v[106:107]
  s_add_u32 s6, s8, k2_first0-k2_pcbase
  s_addc_u32 s7, s9, 0
  v_pk_fma_f32 v[100:101], v[44:45], v[108:109], v[100:101]
  v_pk_fma_f32 v[102:103], v[46:47], v[110:111], v[102:103]
  v_pk_fma_f32 v[104:105], v[48:49], v[112:113], v[104:105]
  v_pk_fma_f32 v[106:107], v[50:51], v[114:115], v[106:107]
  s_sub_u32 s11, s11, 1
  s_cmp_eq_u32 s11, 0
  v_pk_fma_f32 v[108:109], v[108:109], v[60:61], v[108:109]
  v_pk_fma_f32 v[110:111], v[110:111], v[62:63], v[110:111]
  v_pk_fma_f32 v[112:113], v[112:113], v[64:65], v[112:113]
  v_pk_fma_f32 v[114:115], v[114:115], v[66:67], v[114:115]
  s_mov_b64 exec, -1
  s_waitcnt lgkmcnt(0)
  v_mfma_f32_32x32x8bf16_1k v[28:43], v[24:25], v[150:151], v[84:99]
  ds_read_b128 v[148:151], v3 offset:3072
  v_rcp_f32 v76, v108
  v_rcp_f32 v77, v109
  v_rcp_f32 v78, v110
  v_rcp_f32 v79, v111
  v_smfmac_f32_32x32x32_bf16 v[28:43], v[172:175], v[116:123], v178
  ds_read_b128 v[60:63], v240 offset:0
  ds_read_b128 v[64:67], v240 offset:16640
  ds_read_b128 v[68:71], v240 offset:64
  ds_read_b128 v[72:75], v240 offset:16704
  ds_read2_b32 v[236:237], v241 offset0:0 offset1:2
  ds_read2_b32 v[238:239], v241 offset0:4 offset1:6
  v_add_u32 v3, 4096, v3
  v_rcp_f32 v80, v112
  v_rcp_f32 v81, v113
  v_rcp_f32 v82, v114
  v_rcp_f32 v83, v115
  s_cbranch_scc1 k2_lswitch3
  s_setpc_b64 s[4:5]
k2_j3_0:
  s_branch k2_firstg0
k2_j2_0:
  s_branch k2_last0
k2_j1_0:
  s_branch k2_normal0
k2_first0:
  v_mfma_f32_32x32x8bf16_1k v[44:59], v[24:25], v[154:155], v[84:99]
  v_exp_f32 v60, v28
  v_exp_f32 v61, v29
  v_exp_f32 v62, v30
  v_exp_f32 v63, v31
  v_exp_f32 v64, v32
  s_waitcnt vmcnt(10) lgkmcnt(0)
  v_smfmac_f32_32x32x32_bf16 v[44:59], v[172:175], v[124:131], v178
  buffer_load_dwordx4 v[116:119], v148, s[28:31], s16 offen offset:0
  buffer_load_dwordx4 v[120:123], v148, s[28:31], s16 offen offset:64
  ds_read_b128 v[152:155], v3 offset:0
  v_exp_f32 v65, v33
  v_exp_f32 v66, v34
  v_exp_f32 v67, v35
  v_pk_add_f32 v[108:109], v[60:61], 1.0 op_sel_hi:[1,0]
  v_pk_add_f32 v[110:111], v[62:63], 1.0 op_sel_hi:[1,0]
  v_pk_add_f32 v[112:113], v[64:65], 1.0 op_sel_hi:[1,0]
  v_pk_add_f32 v[114:115], v[66:67], 1.0 op_sel_hi:[1,0]
  v_exp_f32 v68, v36
  v_exp_f32 v69, v37
  v_exp_f32 v70, v38
  v_exp_f32 v71, v39
  v_exp_f32 v72, v40
  v_exp_f32 v73, v41
  v_exp_f32 v74, v42
  v_exp_f32 v75, v43
  v_pk_fma_f32 v[100:101], v[28:29], v[68:69], v[28:29]
  v_pk_fma_f32 v[102:103], v[30:31], v[70:71], v[30:31]
  v_pk_fma_f32 v[104:105], v[32:33], v[72:73], v[32:33]
  v_pk_fma_f32 v[106:107], v[34:35], v[74:75], v[34:35]
  v_pk_fma_f32 v[100:101], v[36:37], v[108:109], v[100:101]
  v_pk_fma_f32 v[102:103], v[38:39], v[110:111], v[102:103]
  v_pk_fma_f32 v[104:105], v[40:41], v[112:113], v[104:105]
  v_pk_fma_f32 v[106:107], v[42:43], v[114:115], v[106:107]
  v_pk_fma_f32 v[108:109], v[108:109], v[68:69], v[108:109]
  s_sub_u32 s10, s10, 1
  v_pk_fma_f32 v[110:111], v[110:111], v[70:71], v[110:111]
  v_pk_fma_f32 v[112:113], v[112:113], v[72:73], v[112:113]
  v_pk_fma_f32 v[114:115], v[114:115], v[74:75], v[114:115]
  s_cbranch_scc1 k2_event1
k2_rel0_1:
  v_mfma_f32_32x32x8bf16_1k v[28:43], v[24:25], v[158:159], v[84:99]
  v_exp_f32 v60, v44
  v_exp_f32 v61, v45
  v_exp_f32 v62, v46
  v_exp_f32 v63, v47
  v_exp_f32 v64, v48
  s_waitcnt vmcnt(10) lgkmcnt(0)
  v_smfmac_f32_32x32x32_bf16 v[28:43], v[172:175], v[132:139], v178
  buffer_load_dwordx4 v[124:127], v152, s[28:31], s16 offen offset:0
  buffer_load_dwordx4 v[128:131], v152, s[28:31], s16 offen offset:64
  ds_read_b128 v[156:159], v3 offset:1024
  v_exp_f32 v65, v49
  v_exp_f32 v66, v50
  v_exp_f32 v67, v51
  v_pk_fma_f32 v[100:101], v[100:101], v[60:61], v[100:101]
  v_pk_fma_f32 v[102:103], v[102:103], v[62:63], v[102:103]
  v_pk_fma_f32 v[104:105], v[104:105], v[64:65], v[104:105]
  v_pk_fma_f32 v[106:107], v[106:107], v[66:67], v[106:107]
  v_pk_fma_f32 v[100:101], v[44:45], v[108:109], v[100:101]
  v_pk_fma_f32 v[102:103], v[46:47], v[110:111], v[102:103]
  v_pk_fma_f32 v[104:105], v[48:49], v[112:113], v[104:105]
  v_pk_fma_f32 v[106:107], v[50:51], v[114:115], v[106:107]
  v_exp_f32 v68, v52
  v_exp_f32 v69, v53
  v_exp_f32 v70, v54
  v_exp_f32 v71, v55
  v_exp_f32 v72, v56
  v_exp_f32 v73, v57
  v_exp_f32 v74, v58
  v_exp_f32 v75, v59
  v_pk_fma_f32 v[108:109], v[108:109], v[60:61], v[108:109]
  v_pk_fma_f32 v[110:111], v[110:111], v[62:63], v[110:111]
  v_pk_fma_f32 v[112:113], v[112:113], v[64:65], v[112:113]
  v_pk_fma_f32 v[114:115], v[114:115], v[66:67], v[114:115]
  v_pk_fma_f32 v[100:101], v[100:101], v[68:69], v[100:101]
  v_pk_fma_f32 v[102:103], v[102:103], v[70:71], v[102:103]
  v_pk_fma_f32 v[104:105], v[104:105], v[72:73], v[104:105]
  v_pk_fma_f32 v[106:107], v[106:107], v[74:75], v[106:107]
  v_pk_fma_f32 v[100:101], v[52:53], v[108:109], v[100:101]
  v_pk_fma_f32 v[102:103], v[54:55], v[110:111], v[102:103]
  v_pk_fma_f32 v[104:105], v[56:57], v[112:113], v[104:105]
  v_pk_fma_f32 v[106:107], v[58:59], v[114:115], v[106:107]
  v_pk_fma_f32 v[108:109], v[108:109], v[68:69], v[108:109]
  s_sub_u32 s10, s10, 1
  v_pk_fma_f32 v[110:111], v[110:111], v[70:71], v[110:111]
  v_pk_fma_f32 v[112:113], v[112:113], v[72:73], v[112:113]
  v_pk_fma_f32 v[114:115], v[114:115], v[74:75], v[114:115]
  s_cbranch_scc1 k2_event2
k2_rel1_2:
  v_mfma_f32_32x32x8bf16_1k v[44:59], v[24:25], v[162:163], v[84:99]
  v_exp_f32 v60, v28
  v_exp_f32 v61, v29
  v_exp_f32 v62, v30
  v_exp_f32 v63, v31
  v_exp_f32 v64, v32
  s_waitcnt vmcnt(10) lgkmcnt(0)
  v_smfmac_f32_32x32x32_bf16 v[44:59], v[172:175], v[140:147], v178
  buffer_load_dwordx4 v[132:135], v156, s[28:31], s16 offen offset:0
  buffer_load_dwordx4 v[136:139], v156, s[28:31], s16 offen offset:64
  ds_read_b128 v[160:163], v3 offset:2048
  v_exp_f32 v65, v33
  v_exp_f32 v66, v34
  v_exp_f32 v67, v35
  v_pk_fma_f32 v[100:101], v[100:101], v[60:61], v[100:101]
  v_pk_fma_f32 v[102:103], v[102:103], v[62:63], v[102:103]
  v_pk_fma_f32 v[104:105], v[104:105], v[64:65], v[104:105]
  v_pk_fma_f32 v[106:107], v[106:107], v[66:67], v[106:107]
  v_pk_fma_f32 v[100:101], v[28:29], v[108:109], v[100:101]
  v_pk_fma_f32 v[102:103], v[30:31], v[110:111], v[102:103]
  v_pk_fma_f32 v[104:105], v[32:33], v[112:113], v[104:105]
  v_pk_fma_f32 v[106:107], v[34:35], v[114:115], v[106:107]
  v_exp_f32 v68, v36
  v_exp_f32 v69, v37
  v_exp_f32 v70, v38
  v_exp_f32 v71, v39
  v_exp_f32 v72, v40
  v_exp_f32 v73, v41
  v_exp_f32 v74, v42
  v_exp_f32 v75, v43
  v_pk_fma_f32 v[108:109], v[108:109], v[60:61], v[108:109]
  v_pk_fma_f32 v[110:111], v[110:111], v[62:63], v[110:111]
  v_pk_fma_f32 v[112:113], v[112:113], v[64:65], v[112:113]
  v_pk_fma_f32 v[114:115], v[114:115], v[66:67], v[114:115]
  v_pk_fma_f32 v[100:101], v[100:101], v[68:69], v[100:101]
  v_pk_fma_f32 v[102:103], v[102:103], v[70:71], v[102:103]
  v_pk_fma_f32 v[104:105], v[104:105], v[72:73], v[104:105]
  v_pk_fma_f32 v[106:107], v[106:107], v[74:75], v[106:107]
  v_pk_fma_f32 v[100:101], v[36:37], v[108:109], v[100:101]
  v_pk_fma_f32 v[102:103], v[38:39], v[110:111], v[102:103]
  v_pk_fma_f32 v[104:105], v[40:41], v[112:113], v[104:105]
  v_pk_fma_f32 v[106:107], v[42:43], v[114:115], v[106:107]
  v_pk_fma_f32 v[108:109], v[108:109], v[68:69], v[108:109]
  s_sub_u32 s10, s10, 1
  v_pk_fma_f32 v[110:111], v[110:111], v[70:71], v[110:111]
  v_pk_fma_f32 v[112:113], v[112:113], v[72:73], v[112:113]
  v_pk_fma_f32 v[114:115], v[114:115], v[74:75], v[114:115]
  s_cbranch_scc0 k2_normal3
  s_branch k2_event3
k2_switch0:
  s_mov_b32 m0, s15
  s_add_u32 s15, s15, 1
  s_movrels_b32 s88, s70
  s_movrels_b32 s11, s64
  s_movrels_b32 s16, s76
  s_add_u32 s88, s88, 1024
  s_add_u32 s11, s11, 1
  v_add_u32 v3, s88, v4
  s_cmp_eq_u32 s12, 0
  s_cbranch_scc1 k2_last0
  s_min_u32 s10, s11, s12
  s_sub_u32 s11, s11, s10
  s_sub_u32 s12, s12, s10
  s_cmp_eq_u32 s11, 0
  s_cselect_b64 vcc, -1, 0
  s_sub_u32 s10, s10, 1
  s_branch k2_normal0
k2_lswitch0:
  s_mov_b32 m0, s15
  s_add_u32 s15, s15, 1
  s_movrels_b32 s88, s70
  s_movrels_b32 s11, s64
  s_movrels_b32 s16, s76
  s_add_u32 s88, s88, 0
  s_add_u32 s11, s11, 1
  v_add_u32 v3, s88, v4
  s_setpc_b64 s[4:5]
k2_j3_1:
  s_branch k2_firstg1
k2_j2_1:
  s_branch k2_last1
k2_j1_1:
  s_branch k2_normal1
k2_first1:
  v_mfma_f32_32x32x8bf16_1k v[28:43], v[24:25], v[158:159], v[84:99]
  v_exp_f32 v60, v44
  v_exp_f32 v61, v45
  v_exp_f32 v62, v46
  v_exp_f32 v63, v47
  v_exp_f32 v64, v48
  s_waitcnt vmcnt(10) lgkmcnt(0)
  v_smfmac_f32_32x32x32_bf16 v[28:43], v[172:175], v[132:139], v178
  buffer_load_dwordx4 v[124:127], v152, s[28:31], s16 offen offset:0
  buffer_load_dwordx4 v[128:131], v152, s[28:31], s16 offen offset:64
  ds_read_b128 v[156:159], v3 offset:1024
  v_exp_f32 v65, v49
  v_exp_f32 v66, v50
  v_exp_f32 v67, v51
  v_pk_add_f32 v[108:109], v[60:61], 1.0 op_sel_hi:[1,0]
  v_pk_add_f32 v[110:111], v[62:63], 1.0 op_sel_hi:[1,0]
  v_pk_add_f32 v[112:113], v[64:65], 1.0 op_sel_hi:[1,0]
  v_pk_add_f32 v[114:115], v[66:67], 1.0 op_sel_hi:[1,0]
  v_exp_f32 v68, v52
  v_exp_f32 v69, v53
  v_exp_f32 v70, v54
  v_exp_f32 v71, v55
  v_exp_f32 v72, v56
  v_exp_f32 v73, v57
  v_exp_f32 v74, v58
  v_exp_f32 v75, v59
  v_pk_fma_f32 v[100:101], v[44:45], v[68:69], v[44:45]
  v_pk_fma_f32 v[102:103], v[46:47], v[70:71], v[46:47]
  v_pk_fma_f32 v[104:105], v[48:49], v[72:73], v[48:49]
  v_pk_fma_f32 v[106:107], v[50:51], v[74:75], v[50:51]
  v_pk_fma_f32 v[100:101], v[52:53], v[108:109], v[100:101]
  v_pk_fma_f32 v[102:103], v[54:55], v[110:111], v[102:103]
  v_pk_fma_f32 v[104:105], v[56:57], v[112:113], v[104:105]
  v_pk_fma_f32 v[106:107], v[58:59], v[114:115], v[106:107]
  v_pk_fma_f32 v[108:109], v[108:109], v[68:69], v[108:109]
  s_sub_u32 s10, s10, 1
  v_pk_fma_f32 v[110:111], v[110:111], v[70:71], v[110:111]
  v_pk_fma_f32 v[112:113], v[112:113], v[72:73], v[112:113]
  v_pk_fma_f32 v[114:115], v[114:115], v[74:75], v[114:115]
  s_cbranch_scc1 k2_event2
k2_rel0_2:
  v_mfma_f32_32x32x8bf16_1k v[44:59], v[24:25], v[162:163], v[84:99]
  v_exp_f32 v60, v28
  v_exp_f32 v61, v29
  v_exp_f32 v62, v30
  v_exp_f32 v63, v31
  v_exp_f32 v64, v32
  s_waitcnt vmcnt(10) lgkmcnt(0)
  v_smfmac_f32_32x32x32_bf16 v[44:59], v[172:175], v[140:147], v178
  buffer_load_dwordx4 v[132:135], v156, s[28:31], s16 offen offset:0
  buffer_load_dwordx4 v[136:139], v156, s[28:31], s16 offen offset:64
  ds_read_b128 v[160:163], v3 offset:2048
  v_exp_f32 v65, v33
  v_exp_f32 v66, v34
  v_exp_f32 v67, v35
  v_pk_fma_f32 v[100:101], v[100:101], v[60:61], v[100:101]
  v_pk_fma_f32 v[102:103], v[102:103], v[62:63], v[102:103]
  v_pk_fma_f32 v[104:105], v[104:105], v[64:65], v[104:105]
  v_pk_fma_f32 v[106:107], v[106:107], v[66:67], v[106:107]
  v_pk_fma_f32 v[100:101], v[28:29], v[108:109], v[100:101]
  v_pk_fma_f32 v[102:103], v[30:31], v[110:111], v[102:103]
  v_pk_fma_f32 v[104:105], v[32:33], v[112:113], v[104:105]
  v_pk_fma_f32 v[106:107], v[34:35], v[114:115], v[106:107]
  v_exp_f32 v68, v36
  v_exp_f32 v69, v37
  v_exp_f32 v70, v38
  v_exp_f32 v71, v39
  v_exp_f32 v72, v40
  v_exp_f32 v73, v41
  v_exp_f32 v74, v42
  v_exp_f32 v75, v43
  v_pk_fma_f32 v[108:109], v[108:109], v[60:61], v[108:109]
  v_pk_fma_f32 v[110:111], v[110:111], v[62:63], v[110:111]
  v_pk_fma_f32 v[112:113], v[112:113], v[64:65], v[112:113]
  v_pk_fma_f32 v[114:115], v[114:115], v[66:67], v[114:115]
  v_pk_fma_f32 v[100:101], v[100:101], v[68:69], v[100:101]
  v_pk_fma_f32 v[102:103], v[102:103], v[70:71], v[102:103]
  v_pk_fma_f32 v[104:105], v[104:105], v[72:73], v[104:105]
  v_pk_fma_f32 v[106:107], v[106:107], v[74:75], v[106:107]
  v_pk_fma_f32 v[100:101], v[36:37], v[108:109], v[100:101]
  v_pk_fma_f32 v[102:103], v[38:39], v[110:111], v[102:103]
  v_pk_fma_f32 v[104:105], v[40:41], v[112:113], v[104:105]
  v_pk_fma_f32 v[106:107], v[42:43], v[114:115], v[106:107]
  v_pk_fma_f32 v[108:109], v[108:109], v[68:69], v[108:109]
  s_sub_u32 s10, s10, 1
  v_pk_fma_f32 v[110:111], v[110:111], v[70:71], v[110:111]
  v_pk_fma_f32 v[112:113], v[112:113], v[72:73], v[112:113]
  v_pk_fma_f32 v[114:115], v[114:115], v[74:75], v[114:115]
  s_cbranch_scc1 k2_event3
k2_rel1_3:
  v_mfma_f32_32x32x8bf16_1k v[28:43], v[24:25], v[150:151], v[84:99]
  v_exp_f32 v60, v44
  v_exp_f32 v61, v45
  v_exp_f32 v62, v46
  v_exp_f32 v63, v47
  v_exp_f32 v64, v48
  s_waitcnt vmcnt(10) lgkmcnt(0)
  v_smfmac_f32_32x32x32_bf16 v[28:43], v[172:175], v[116:123], v178
  buffer_load_dwordx4 v[140:143], v160, s[28:31], s16 offen offset:0
  buffer_load_dwordx4 v[144:147], v160, s[28:31], s16 offen offset:64
  ds_read_b128 v[148:151], v3 offset:3072
  v_exp_f32 v65, v49
  v_exp_f32 v66, v50
  v_exp_f32 v67, v51
  v_pk_fma_f32 v[100:101], v[100:101], v[60:61], v[100:101]
  v_pk_fma_f32 v[102:103], v[102:103], v[62:63], v[102:103]
  v_pk_fma_f32 v[104:105], v[104:105], v[64:65], v[104:105]
  v_pk_fma_f32 v[106:107], v[106:107], v[66:67], v[106:107]
  v_pk_fma_f32 v[100:101], v[44:45], v[108:109], v[100:101]
  v_pk_fma_f32 v[102:103], v[46:47], v[110:111], v[102:103]
  v_pk_fma_f32 v[104:105], v[48:49], v[112:113], v[104:105]
  v_pk_fma_f32 v[106:107], v[50:51], v[114:115], v[106:107]
  v_add_u32 v3, 4096, v3
  v_exp_f32 v68, v52
  v_exp_f32 v69, v53
  v_exp_f32 v70, v54
  v_exp_f32 v71, v55
  v_exp_f32 v72, v56
  v_exp_f32 v73, v57
  v_exp_f32 v74, v58
  v_exp_f32 v75, v59
  v_pk_fma_f32 v[108:109], v[108:109], v[60:61], v[108:109]
  v_pk_fma_f32 v[110:111], v[110:111], v[62:63], v[110:111]
  v_pk_fma_f32 v[112:113], v[112:113], v[64:65], v[112:113]
  v_pk_fma_f32 v[114:115], v[114:115], v[66:67], v[114:115]
  v_pk_fma_f32 v[100:101], v[100:101], v[68:69], v[100:101]
  v_pk_fma_f32 v[102:103], v[102:103], v[70:71], v[102:103]
  v_pk_fma_f32 v[104:105], v[104:105], v[72:73], v[104:105]
  v_pk_fma_f32 v[106:107], v[106:107], v[74:75], v[106:107]
  v_pk_fma_f32 v[100:101], v[52:53], v[108:109], v[100:101]
  v_pk_fma_f32 v[102:103], v[54:55], v[110:111], v[102:103]
  v_pk_fma_f32 v[104:105], v[56:57], v[112:113], v[104:105]
  v_pk_fma_f32 v[106:107], v[58:59], v[114:115], v[106:107]
  v_pk_fma_f32 v[108:109], v[108:109], v[68:69], v[108:109]
  s_sub_u32 s10, s10, 1
  v_pk_fma_f32 v[110:111], v[110:111], v[70:71], v[110:111]
  v_pk_fma_f32 v[112:113], v[112:113], v[72:73], v[112:113]
  v_pk_fma_f32 v[114:115], v[114:115], v[74:75], v[114:115]
  s_cbranch_scc0 k2_normal0
  s_branch k2_event0
k2_switch1:
  s_mov_b32 m0, s15
  s_add_u32 s15, s15, 1
  s_movrels_b32 s88, s70
  s_movrels_b32 s11, s64
  s_movrels_b32 s16, s76
  s_add_u32 s88, s88, 0
  s_add_u32 s11, s11, 1
  v_add_u32 v3, s88, v4
  s_cmp_eq_u32 s12, 0
  s_cbranch_scc1 k2_last1
  s_min_u32 s10, s11, s12
  s_sub_u32 s11, s11, s10
  s_sub_u32 s12, s12, s10
  s_cmp_eq_u32 s11, 0
  s_cselect_b64 vcc, -1, 0
  s_sub_u32 s10, s10, 1
  s_branch k2_normal1
k2_lswitch1:
  s_mov_b32 m0, s15
  s_add_u32 s15, s15, 1
  s_movrels_b32 s88, s70
  s_movrels_b32 s11, s64
  s_movrels_b32 s16, s76
  s_add_u32 s88, s88, 4294966272
  s_add_u32 s11, s11, 1
  v_add_u32 v3, s88, v4
  s_setpc_b64 s[4:5]
k2_j3_2:
  s_branch k2_firstg2
k2_j2_2:
  s_branch k2_last2
k2_j1_2:
  s_branch k2_normal2
k2_first2:
  v_mfma_f32_32x32x8bf16_1k v[44:59], v[24:25], v[162:163], v[84:99]
  v_exp_f32 v60, v28
  v_exp_f32 v61, v29
  v_exp_f32 v62, v30
  v_exp_f32 v63, v31
  v_exp_f32 v64, v32
  s_waitcnt vmcnt(10) lgkmcnt(0)
  v_smfmac_f32_32x32x32_bf16 v[44:59], v[172:175], v[140:147], v178
  buffer_load_dwordx4 v[132:135], v156, s[28:31], s16 offen offset:0
  buffer_load_dwordx4 v[136:139], v156, s[28:31], s16 offen offset:64
  ds_read_b128 v[160:163], v3 offset:2048
  v_exp_f32 v65, v33
  v_exp_f32 v66, v34
  v_exp_f32 v67, v35
  v_pk_add_f32 v[108:109], v[60:61], 1.0 op_sel_hi:[1,0]
  v_pk_add_f32 v[110:111], v[62:63], 1.0 op_sel_hi:[1,0]
  v_pk_add_f32 v[112:113], v[64:65], 1.0 op_sel_hi:[1,0]
  v_pk_add_f32 v[114:115], v[66:67], 1.0 op_sel_hi:[1,0]
  v_exp_f32 v68, v36
  v_exp_f32 v69, v37
  v_exp_f32 v70, v38
  v_exp_f32 v71, v39
  v_exp_f32 v72, v40
  v_exp_f32 v73, v41
  v_exp_f32 v74, v42
  v_exp_f32 v75, v43
  v_pk_fma_f32 v[100:101], v[28:29], v[68:69], v[28:29]
  v_pk_fma_f32 v[102:103], v[30:31], v[70:71], v[30:31]
  v_pk_fma_f32 v[104:105], v[32:33], v[72:73], v[32:33]
  v_pk_fma_f32 v[106:107], v[34:35], v[74:75], v[34:35]
  v_pk_fma_f32 v[100:101], v[36:37], v[108:109], v[100:101]
  v_pk_fma_f32 v[102:103], v[38:39], v[110:111], v[102:103]
  v_pk_fma_f32 v[104:105], v[40:41], v[112:113], v[104:105]
  v_pk_fma_f32 v[106:107], v[42:43], v[114:115], v[106:107]
  v_pk_fma_f32 v[108:109], v[108:109], v[68:69], v[108:109]
  s_sub_u32 s10, s10, 1
  v_pk_fma_f32 v[110:111], v[110:111], v[70:71], v[110:111]
  v_pk_fma_f32 v[112:113], v[112:113], v[72:73], v[112:113]
  v_pk_fma_f32 v[114:115], v[114:115], v[74:75], v[114:115]
  s_cbranch_scc1 k2_event3
k2_rel0_3:
  v_mfma_f32_32x32x8bf16_1k v[28:43], v[24:25], v[150:151], v[84:99]
  v_exp_f32 v60, v44
  v_exp_f32 v61, v45
  v_exp_f32 v62, v46
  v_exp_f32 v63, v47
  v_exp_f32 v64, v48
  s_waitcnt vmcnt(10) lgkmcnt(0)
  v_smfmac_f32_32x32x32_bf16 v[28:43], v[172:175], v[116:123], v178
  buffer_load_dwordx4 v[140:143], v160, s[28:31], s16 offen offset:0
  buffer_load_dwordx4 v[144:147], v160, s[28:31], s16 offen offset:64
  ds_read_b128 v[148:151], v3 offset:3072
  v_exp_f32 v65, v49
  v_exp_f32 v66, v50
  v_exp_f32 v67, v51
  v_pk_fma_f32 v[100:101], v[100:101], v[60:61], v[100:101]
  v_pk_fma_f32 v[102:103], v[102:103], v[62:63], v[102:103]
  v_pk_fma_f32 v[104:105], v[104:105], v[64:65], v[104:105]
  v_pk_fma_f32 v[106:107], v[106:107], v[66:67], v[106:107]
  v_pk_fma_f32 v[100:101], v[44:45], v[108:109], v[100:101]
  v_pk_fma_f32 v[102:103], v[46:47], v[110:111], v[102:103]
  v_pk_fma_f32 v[104:105], v[48:49], v[112:113], v[104:105]
  v_pk_fma_f32 v[106:107], v[50:51], v[114:115], v[106:107]
  v_add_u32 v3, 4096, v3
  v_exp_f32 v68, v52
  v_exp_f32 v69, v53
  v_exp_f32 v70, v54
  v_exp_f32 v71, v55
  v_exp_f32 v72, v56
  v_exp_f32 v73, v57
  v_exp_f32 v74, v58
  v_exp_f32 v75, v59
  v_pk_fma_f32 v[108:109], v[108:109], v[60:61], v[108:109]
  v_pk_fma_f32 v[110:111], v[110:111], v[62:63], v[110:111]
  v_pk_fma_f32 v[112:113], v[112:113], v[64:65], v[112:113]
  v_pk_fma_f32 v[114:115], v[114:115], v[66:67], v[114:115]
  v_pk_fma_f32 v[100:101], v[100:101], v[68:69], v[100:101]
  v_pk_fma_f32 v[102:103], v[102:103], v[70:71], v[102:103]
  v_pk_fma_f32 v[104:105], v[104:105], v[72:73], v[104:105]
  v_pk_fma_f32 v[106:107], v[106:107], v[74:75], v[106:107]
  v_pk_fma_f32 v[100:101], v[52:53], v[108:109], v[100:101]
  v_pk_fma_f32 v[102:103], v[54:55], v[110:111], v[102:103]
  v_pk_fma_f32 v[104:105], v[56:57], v[112:113], v[104:105]
  v_pk_fma_f32 v[106:107], v[58:59], v[114:115], v[106:107]
  v_pk_fma_f32 v[108:109], v[108:109], v[68:69], v[108:109]
  s_sub_u32 s10, s10, 1
  v_pk_fma_f32 v[110:111], v[110:111], v[70:71], v[110:111]
  v_pk_fma_f32 v[112:113], v[112:113], v[72:73], v[112:113]
  v_pk_fma_f32 v[114:115], v[114:115], v[74:75], v[114:115]
  s_cbranch_scc1 k2_event0
k2_rel1_0:
  v_mfma_f32_32x32x8bf16_1k v[44:59], v[24:25], v[154:155], v[84:99]
  v_exp_f32 v60, v28
  v_exp_f32 v61, v29
  v_exp_f32 v62, v30
  v_exp_f32 v63, v31
  v_exp_f32 v64, v32
  s_waitcnt vmcnt(10) lgkmcnt(0)
  v_smfmac_f32_32x32x32_bf16 v[44:59], v[172:175], v[124:131], v178
  buffer_load_dwordx4 v[116:119], v148, s[28:31], s16 offen offset:0
  buffer_load_dwordx4 v[120:123], v148, s[28:31], s16 offen offset:64
  ds_read_b128 v[152:155], v3 offset:0
  v_exp_f32 v65, v33
  v_exp_f32 v66, v34
  v_exp_f32 v67, v35
  v_pk_fma_f32 v[100:101], v[100:101], v[60:61], v[100:101]
  v_pk_fma_f32 v[102:103], v[102:103], v[62:63], v[102:103]
  v_pk_fma_f32 v[104:105], v[104:105], v[64:65], v[104:105]
  v_pk_fma_f32 v[106:107], v[106:107], v[66:67], v[106:107]
  v_pk_fma_f32 v[100:101], v[28:29], v[108:109], v[100:101]
  v_pk_fma_f32 v[102:103], v[30:31], v[110:111], v[102:103]
  v_pk_fma_f32 v[104:105], v[32:33], v[112:113], v[104:105]
  v_pk_fma_f32 v[106:107], v[34:35], v[114:115], v[106:107]
  v_exp_f32 v68, v36
  v_exp_f32 v69, v37
  v_exp_f32 v70, v38
  v_exp_f32 v71, v39
  v_exp_f32 v72, v40
  v_exp_f32 v73, v41
  v_exp_f32 v74, v42
  v_exp_f32 v75, v43
  v_pk_fma_f32 v[108:109], v[108:109], v[60:61], v[108:109]
  v_pk_fma_f32 v[110:111], v[110:111], v[62:63], v[110:111]
  v_pk_fma_f32 v[112:113], v[112:113], v[64:65], v[112:113]
  v_pk_fma_f32 v[114:115], v[114:115], v[66:67], v[114:115]
  v_pk_fma_f32 v[100:101], v[100:101], v[68:69], v[100:101]
  v_pk_fma_f32 v[102:103], v[102:103], v[70:71], v[102:103]
  v_pk_fma_f32 v[104:105], v[104:105], v[72:73], v[104:105]
  v_pk_fma_f32 v[106:107], v[106:107], v[74:75], v[106:107]
  v_pk_fma_f32 v[100:101], v[36:37], v[108:109], v[100:101]
  v_pk_fma_f32 v[102:103], v[38:39], v[110:111], v[102:103]
  v_pk_fma_f32 v[104:105], v[40:41], v[112:113], v[104:105]
  v_pk_fma_f32 v[106:107], v[42:43], v[114:115], v[106:107]
  v_pk_fma_f32 v[108:109], v[108:109], v[68:69], v[108:109]
  s_sub_u32 s10, s10, 1
  v_pk_fma_f32 v[110:111], v[110:111], v[70:71], v[110:111]
  v_pk_fma_f32 v[112:113], v[112:113], v[72:73], v[112:113]
  v_pk_fma_f32 v[114:115], v[114:115], v[74:75], v[114:115]
  s_cbranch_scc0 k2_normal1
  s_branch k2_event1
k2_switch2:
  s_mov_b32 m0, s15
  s_add_u32 s15, s15, 1
  s_movrels_b32 s88, s70
  s_movrels_b32 s11, s64
  s_movrels_b32 s16, s76
  s_add_u32 s88, s88, 4294966272
  s_add_u32 s11, s11, 1
  v_add_u32 v3, s88, v4
  s_cmp_eq_u32 s12, 0
  s_cbranch_scc1 k2_last2
  s_min_u32 s10, s11, s12
  s_sub_u32 s11, s11, s10
  s_sub_u32 s12, s12, s10
  s_cmp_eq_u32 s11, 0
  s_cselect_b64 vcc, -1, 0
  s_sub_u32 s10, s10, 1
  s_branch k2_normal2
k2_lswitch2:
  s_mov_b32 m0, s15
  s_add_u32 s15, s15, 1
  s_movrels_b32 s88, s70
  s_movrels_b32 s11, s64
  s_movrels_b32 s16, s76
  s_add_u32 s88, s88, 4294965248
  s_add_u32 s11, s11, 1
  v_add_u32 v3, s88, v4
  s_setpc_b64 s[4:5]
k2_j3_3:
  s_branch k2_firstg3
k2_j2_3:
  s_branch k2_last3
k2_j1_3:
  s_branch k2_normal3
k2_first3:
  v_mfma_f32_32x32x8bf16_1k v[28:43], v[24:25], v[150:151], v[84:99]
  v_exp_f32 v60, v44
  v_exp_f32 v61, v45
  v_exp_f32 v62, v46
  v_exp_f32 v63, v47
  v_exp_f32 v64, v48
  s_waitcnt vmcnt(10) lgkmcnt(0)
  v_smfmac_f32_32x32x32_bf16 v[28:43], v[172:175], v[116:123], v178
  buffer_load_dwordx4 v[140:143], v160, s[28:31], s16 offen offset:0
  buffer_load_dwordx4 v[144:147], v160, s[28:31], s16 offen offset:64
  ds_read_b128 v[148:151], v3 offset:3072
  v_exp_f32 v65, v49
  v_exp_f32 v66, v50
  v_exp_f32 v67, v51
  v_pk_add_f32 v[108:109], v[60:61], 1.0 op_sel_hi:[1,0]
  v_pk_add_f32 v[110:111], v[62:63], 1.0 op_sel_hi:[1,0]
  v_pk_add_f32 v[112:113], v[64:65], 1.0 op_sel_hi:[1,0]
  v_pk_add_f32 v[114:115], v[66:67], 1.0 op_sel_hi:[1,0]
  v_add_u32 v3, 4096, v3
  v_exp_f32 v68, v52
  v_exp_f32 v69, v53
  v_exp_f32 v70, v54
  v_exp_f32 v71, v55
  v_exp_f32 v72, v56
  v_exp_f32 v73, v57
  v_exp_f32 v74, v58
  v_exp_f32 v75, v59
  v_pk_fma_f32 v[100:101], v[44:45], v[68:69], v[44:45]
  v_pk_fma_f32 v[102:103], v[46:47], v[70:71], v[46:47]
  v_pk_fma_f32 v[104:105], v[48:49], v[72:73], v[48:49]
  v_pk_fma_f32 v[106:107], v[50:51], v[74:75], v[50:51]
  v_pk_fma_f32 v[100:101], v[52:53], v[108:109], v[100:101]
  v_pk_fma_f32 v[102:103], v[54:55], v[110:111], v[102:103]
  v_pk_fma_f32 v[104:105], v[56:57], v[112:113], v[104:105]
  v_pk_fma_f32 v[106:107], v[58:59], v[114:115], v[106:107]
  v_pk_fma_f32 v[108:109], v[108:109], v[68:69], v[108:109]
  s_sub_u32 s10, s10, 1
  v_pk_fma_f32 v[110:111], v[110:111], v[70:71], v[110:111]
  v_pk_fma_f32 v[112:113], v[112:113], v[72:73], v[112:113]
  v_pk_fma_f32 v[114:115], v[114:115], v[74:75], v[114:115]
  s_cbranch_scc1 k2_event0
k2_rel0_0:
  v_mfma_f32_32x32x8bf16_1k v[44:59], v[24:25], v[154:155], v[84:99]
  v_exp_f32 v60, v28
  v_exp_f32 v61, v29
  v_exp_f32 v62, v30
  v_exp_f32 v63, v31
  v_exp_f32 v64, v32
  s_waitcnt vmcnt(10) lgkmcnt(0)
  v_smfmac_f32_32x32x32_bf16 v[44:59], v[172:175], v[124:131], v178
  buffer_load_dwordx4 v[116:119], v148, s[28:31], s16 offen offset:0
  buffer_load_dwordx4 v[120:123], v148, s[28:31], s16 offen offset:64
  ds_read_b128 v[152:155], v3 offset:0
  v_exp_f32 v65, v33
  v_exp_f32 v66, v34
  v_exp_f32 v67, v35
  v_pk_fma_f32 v[100:101], v[100:101], v[60:61], v[100:101]
  v_pk_fma_f32 v[102:103], v[102:103], v[62:63], v[102:103]
  v_pk_fma_f32 v[104:105], v[104:105], v[64:65], v[104:105]
  v_pk_fma_f32 v[106:107], v[106:107], v[66:67], v[106:107]
  v_pk_fma_f32 v[100:101], v[28:29], v[108:109], v[100:101]
  v_pk_fma_f32 v[102:103], v[30:31], v[110:111], v[102:103]
  v_pk_fma_f32 v[104:105], v[32:33], v[112:113], v[104:105]
  v_pk_fma_f32 v[106:107], v[34:35], v[114:115], v[106:107]
  v_exp_f32 v68, v36
  v_exp_f32 v69, v37
  v_exp_f32 v70, v38
  v_exp_f32 v71, v39
  v_exp_f32 v72, v40
  v_exp_f32 v73, v41
  v_exp_f32 v74, v42
  v_exp_f32 v75, v43
  v_pk_fma_f32 v[108:109], v[108:109], v[60:61], v[108:109]
  v_pk_fma_f32 v[110:111], v[110:111], v[62:63], v[110:111]
  v_pk_fma_f32 v[112:113], v[112:113], v[64:65], v[112:113]
  v_pk_fma_f32 v[114:115], v[114:115], v[66:67], v[114:115]
  v_pk_fma_f32 v[100:101], v[100:101], v[68:69], v[100:101]
  v_pk_fma_f32 v[102:103], v[102:103], v[70:71], v[102:103]
  v_pk_fma_f32 v[104:105], v[104:105], v[72:73], v[104:105]
  v_pk_fma_f32 v[106:107], v[106:107], v[74:75], v[106:107]
  v_pk_fma_f32 v[100:101], v[36:37], v[108:109], v[100:101]
  v_pk_fma_f32 v[102:103], v[38:39], v[110:111], v[102:103]
  v_pk_fma_f32 v[104:105], v[40:41], v[112:113], v[104:105]
  v_pk_fma_f32 v[106:107], v[42:43], v[114:115], v[106:107]
  v_pk_fma_f32 v[108:109], v[108:109], v[68:69], v[108:109]
  s_sub_u32 s10, s10, 1
  v_pk_fma_f32 v[110:111], v[110:111], v[70:71], v[110:111]
  v_pk_fma_f32 v[112:113], v[112:113], v[72:73], v[112:113]
  v_pk_fma_f32 v[114:115], v[114:115], v[74:75], v[114:115]
  s_cbranch_scc1 k2_event1
k2_rel1_1:
  v_mfma_f32_32x32x8bf16_1k v[28:43], v[24:25], v[158:159], v[84:99]
  v_exp_f32 v60, v44
  v_exp_f32 v61, v45
  v_exp_f32 v62, v46
  v_exp_f32 v63, v47
  v_exp_f32 v64, v48
  s_waitcnt vmcnt(10) lgkmcnt(0)
  v_smfmac_f32_32x32x32_bf16 v[28:43], v[172:175], v[132:139], v178
  buffer_load_dwordx4 v[124:127], v152, s[28:31], s16 offen offset:0
  buffer_load_dwordx4 v[128:131], v152, s[28:31], s16 offen offset:64
  ds_read_b128 v[156:159], v3 offset:1024
  v_exp_f32 v65, v49
  v_exp_f32 v66, v50
  v_exp_f32 v67, v51
  v_pk_fma_f32 v[100:101], v[100:101], v[60:61], v[100:101]
  v_pk_fma_f32 v[102:103], v[102:103], v[62:63], v[102:103]
  v_pk_fma_f32 v[104:105], v[104:105], v[64:65], v[104:105]
  v_pk_fma_f32 v[106:107], v[106:107], v[66:67], v[106:107]
  v_pk_fma_f32 v[100:101], v[44:45], v[108:109], v[100:101]
  v_pk_fma_f32 v[102:103], v[46:47], v[110:111], v[102:103]
  v_pk_fma_f32 v[104:105], v[48:49], v[112:113], v[104:105]
  v_pk_fma_f32 v[106:107], v[50:51], v[114:115], v[106:107]
  v_exp_f32 v68, v52
  v_exp_f32 v69, v53
  v_exp_f32 v70, v54
  v_exp_f32 v71, v55
  v_exp_f32 v72, v56
  v_exp_f32 v73, v57
  v_exp_f32 v74, v58
  v_exp_f32 v75, v59
  v_pk_fma_f32 v[108:109], v[108:109], v[60:61], v[108:109]
  v_pk_fma_f32 v[110:111], v[110:111], v[62:63], v[110:111]
  v_pk_fma_f32 v[112:113], v[112:113], v[64:65], v[112:113]
  v_pk_fma_f32 v[114:115], v[114:115], v[66:67], v[114:115]
  v_pk_fma_f32 v[100:101], v[100:101], v[68:69], v[100:101]
  v_pk_fma_f32 v[102:103], v[102:103], v[70:71], v[102:103]
  v_pk_fma_f32 v[104:105], v[104:105], v[72:73], v[104:105]
  v_pk_fma_f32 v[106:107], v[106:107], v[74:75], v[106:107]
  v_pk_fma_f32 v[100:101], v[52:53], v[108:109], v[100:101]
  v_pk_fma_f32 v[102:103], v[54:55], v[110:111], v[102:103]
  v_pk_fma_f32 v[104:105], v[56:57], v[112:113], v[104:105]
  v_pk_fma_f32 v[106:107], v[58:59], v[114:115], v[106:107]
  v_pk_fma_f32 v[108:109], v[108:109], v[68:69], v[108:109]
  s_sub_u32 s10, s10, 1
  v_pk_fma_f32 v[110:111], v[110:111], v[70:71], v[110:111]
  v_pk_fma_f32 v[112:113], v[112:113], v[72:73], v[112:113]
  v_pk_fma_f32 v[114:115], v[114:115], v[74:75], v[114:115]
  s_cbranch_scc0 k2_normal2
  s_branch k2_event2
k2_switch3:
  s_mov_b32 m0, s15
  s_add_u32 s15, s15, 1
  s_movrels_b32 s88, s70
  s_movrels_b32 s11, s64
  s_movrels_b32 s16, s76
  s_add_u32 s88, s88, 4294965248
  s_add_u32 s11, s11, 1
  v_add_u32 v3, s88, v4
  s_cmp_eq_u32 s12, 0
  s_cbranch_scc1 k2_last3
  s_min_u32 s10, s11, s12
  s_sub_u32 s11, s11, s10
  s_sub_u32 s12, s12, s10
  s_cmp_eq_u32 s11, 0
  s_cselect_b64 vcc, -1, 0
  s_sub_u32 s10, s10, 1
  s_branch k2_normal3
k2_lswitch3:
  s_mov_b32 m0, s15
  s_add_u32 s15, s15, 1
  s_movrels_b32 s88, s70
  s_movrels_b32 s11, s64
  s_movrels_b32 s16, s76
  s_add_u32 s88, s88, 1024
  s_add_u32 s11, s11, 1
  v_add_u32 v3, s88, v4
  s_setpc_b64 s[4:5]
k2_bound0:
  v_maximum3_f32 v9, v9, v108, abs(v100)
  v_maximum3_f32 v9, v9, v109, abs(v101)
  v_maximum3_f32 v9, v9, v110, abs(v102)
  v_maximum3_f32 v9, v9, v111, abs(v103)
  v_maximum3_f32 v9, v9, v112, abs(v104)
  v_maximum3_f32 v9, v9, v113, abs(v105)
  v_maximum3_f32 v9, v9, v114, abs(v106)
  v_maximum3_f32 v9, v9, v115, abs(v107)
  v_pk_mul_f32 v[100:101], v[100:101], v[76:77]
  v_pk_mul_f32 v[102:103], v[102:103], v[78:79]
  v_pk_mul_f32 v[104:105], v[104:105], v[80:81]
  v_pk_mul_f32 v[106:107], v[106:107], v[82:83]
  v_add_u32 v14, s18, v5
  v_cvt_pk_bf16_f32 v100, v100, v101
  v_cvt_pk_bf16_f32 v101, v102, v103
  v_cvt_pk_bf16_f32 v102, v104, v105
  v_cvt_pk_bf16_f32 v103, v106, v107
  v_add_u32 v15, 256, v15
  ds_write_b64 v14, v[100:101]
  ds_write_b64 v14, v[102:103] offset:64
  ds_add_u32 v15, v12
  s_lshr_b32 s90, s84, 16
  v_add_u32 v7, s90, v6
  v_lshrrev_b32 v8, 16, v19
  v_mad_u32_u16 v13, v21, s95, v2
  s_mov_b32 s17, s79
  s_add_u32 s4, s8, k2_bound1-k2_pcbase
  s_addc_u32 s5, s9, 0
  s_lshl_b32 s13, s65, 1
  s_and_b32 s14, s83, 1
  s_min_u32 s10, s11, s65
  s_sub_u32 s11, s11, s10
  s_sub_u32 s12, s65, s10
  s_cmp_eq_u32 s11, 0
  s_cselect_b64 vcc, -1, 0
  s_sub_u32 s10, s10, 1
  s_waitcnt lgkmcnt(3)
  s_add_u32 s88, s92, 0
  s_bitcmp1_b32 s83, 1
  buffer_load_dwordx4 v[204:207], v4, s[36:39], s88 offen offset:0
  buffer_load_dwordx4 v[212:215], v4, s[36:39], s88 offen offset:1024
  buffer_load_dwordx4 v[208:211], v4, s[36:39], s88 offen offset:2048
  buffer_load_dwordx4 v[216:219], v4, s[36:39], s88 offen offset:3072
  s_setprio 2
  s_cbranch_scc1 k2_rare
  s_setpc_b64 s[6:7]
k2_bound1:
  v_readfirstlane_b32 s88, v16
  v_maximum3_f32 v9, v9, v108, abs(v100)
  s_cmp_lt_u32 s88, 8
  v_maximum3_f32 v9, v9, v109, abs(v101)
  v_maximum3_f32 v9, v9, v110, abs(v102)
  v_maximum3_f32 v9, v9, v111, abs(v103)
  s_cbranch_scc1 k2_poll1
k2_polled1:
  s_waitcnt lgkmcnt(5)
  v_mfma_f32_16x16x32_bf16 v[180:183], v[60:63], v[204:207], v[180:183]
  v_maximum3_f32 v9, v9, v112, abs(v104)
  v_maximum3_f32 v9, v9, v113, abs(v105)
  v_mfma_f32_16x16x32_bf16 v[184:187], v[60:63], v[212:215], v[184:187]
  v_maximum3_f32 v9, v9, v114, abs(v106)
  v_maximum3_f32 v9, v9, v115, abs(v107)
  s_waitcnt lgkmcnt(4)
  v_mfma_f32_16x16x32_bf16 v[188:191], v[64:67], v[204:207], v[188:191]
  v_mul_f32 v100, v100, v76
  v_mul_f32 v101, v101, v77
  v_mfma_f32_16x16x32_bf16 v[192:195], v[64:67], v[212:215], v[192:195]
  v_mul_f32 v102, v102, v78
  v_mul_f32 v103, v103, v79
  s_waitcnt lgkmcnt(3)
  v_mfma_f32_16x16x32_bf16 v[180:183], v[68:71], v[208:211], v[180:183]
  v_mul_f32 v104, v104, v80
  v_mul_f32 v105, v105, v81
  v_mfma_f32_16x16x32_bf16 v[184:187], v[68:71], v[216:219], v[184:187]
  v_mul_f32 v106, v106, v82
  v_mul_f32 v107, v107, v83
  s_waitcnt lgkmcnt(2)
  v_mfma_f32_16x16x32_bf16 v[188:191], v[72:75], v[208:211], v[188:191]
  v_add_u32 v14, s19, v5
  v_cvt_pk_bf16_f32 v100, v100, v101
  v_mfma_f32_16x16x32_bf16 v[192:195], v[72:75], v[216:219], v[192:195]
  v_cvt_pk_bf16_f32 v101, v102, v103
  v_cvt_pk_bf16_f32 v102, v104, v105
  s_waitcnt lgkmcnt(0)
  v_smfmac_f32_16x16x64_bf16 v[196:199], v[236:239], v[204:211], v242
  v_cvt_pk_bf16_f32 v103, v106, v107
  v_add_u32 v15, 256, v15
  v_smfmac_f32_16x16x64_bf16 v[200:203], v[236:239], v[212:219], v242
  ds_write_b64 v14, v[100:101]
  ds_write_b64 v14, v[102:103] offset:64
  ds_add_u32 v15, v12
  s_lshr_b32 s90, s85, 16
  v_add_u32 v7, s90, v6
  v_lshrrev_b32 v8, 16, v20
  v_mad_u32_u16 v13, v22, s95, v2
  s_mov_b32 s17, s80
  s_add_u32 s4, s8, k2_bound2-k2_pcbase
  s_addc_u32 s5, s9, 0
  s_lshl_b32 s13, s66, 1
  s_and_b32 s14, s84, 1
  s_min_u32 s10, s11, s66
  s_sub_u32 s11, s11, s10
  s_sub_u32 s12, s66, s10
  s_cmp_eq_u32 s11, 0
  s_cselect_b64 vcc, -1, 0
  s_sub_u32 s10, s10, 1
  v_add_u32 v240, 128, v240
  v_add_u32 v241, 128, v241
  s_add_u32 s88, s92, 4096
  s_add_u32 s89, s92, 8192
  s_cmp_lt_u32 s26, 4
  buffer_load_dwordx4 v[204:207], v4, s[36:39], s88 offen offset:0
  buffer_load_dwordx4 v[212:215], v4, s[36:39], s88 offen offset:1024
  buffer_load_dwordx4 v[208:211], v4, s[36:39], s88 offen offset:2048
  buffer_load_dwordx4 v[216:219], v4, s[36:39], s88 offen offset:3072
  buffer_load_dwordx4 v[220:223], v4, s[36:39], s89 offen offset:0
  buffer_load_dwordx4 v[228:231], v4, s[36:39], s89 offen offset:1024
  buffer_load_dwordx4 v[224:227], v4, s[36:39], s89 offen offset:2048
  buffer_load_dwordx4 v[232:235], v4, s[36:39], s89 offen offset:3072
  s_setprio 1
  s_cbranch_scc1 k2_prio2
  s_setprio 2
k2_prio2:
  s_bitcmp1_b32 s84, 1
  s_nop 1
  s_cbranch_scc1 k2_rare
  s_setpc_b64 s[6:7]
k2_bound2:
  v_readfirstlane_b32 s88, v16
  v_maximum3_f32 v9, v9, v108, abs(v100)
  s_cmp_lt_u32 s88, 8
  v_maximum3_f32 v9, v9, v109, abs(v101)
  v_maximum3_f32 v9, v9, v110, abs(v102)
  v_maximum3_f32 v9, v9, v111, abs(v103)
  s_cbranch_scc1 k2_poll2
k2_polled2:
  s_waitcnt lgkmcnt(5)
  v_mfma_f32_16x16x32_bf16 v[180:183], v[60:63], v[204:207], v[180:183]
  v_maximum3_f32 v9, v9, v112, abs(v104)
  v_maximum3_f32 v9, v9, v113, abs(v105)
  v_mfma_f32_16x16x32_bf16 v[184:187], v[60:63], v[212:215], v[184:187]
  ds_read_b128 v[60:63], v240 offset:128
  v_maximum3_f32 v9, v9, v114, abs(v106)
  v_maximum3_f32 v9, v9, v115, abs(v107)
  s_waitcnt lgkmcnt(5)
  v_mfma_f32_16x16x32_bf16 v[188:191], v[64:67], v[204:207], v[188:191]
  v_mul_f32 v100, v100, v76
  v_mul_f32 v101, v101, v77
  v_mfma_f32_16x16x32_bf16 v[192:195], v[64:67], v[212:215], v[192:195]
  ds_read_b128 v[64:67], v240 offset:16768
  v_mul_f32 v102, v102, v78
  v_mul_f32 v103, v103, v79
  s_waitcnt lgkmcnt(5)
  v_mfma_f32_16x16x32_bf16 v[180:183], v[68:71], v[208:211], v[180:183]
  v_mul_f32 v104, v104, v80
  v_mul_f32 v105, v105, v81
  v_mfma_f32_16x16x32_bf16 v[184:187], v[68:71], v[216:219], v[184:187]
  ds_read_b128 v[68:71], v240 offset:192
  v_mul_f32 v106, v106, v82
  v_mul_f32 v107, v107, v83
  s_waitcnt lgkmcnt(5)
  v_mfma_f32_16x16x32_bf16 v[188:191], v[72:75], v[208:211], v[188:191]
  v_add_u32 v14, s20, v5
  v_cvt_pk_bf16_f32 v100, v100, v101
  v_mfma_f32_16x16x32_bf16 v[192:195], v[72:75], v[216:219], v[192:195]
  ds_read_b128 v[72:75], v240 offset:16832
  v_cvt_pk_bf16_f32 v101, v102, v103
  v_cvt_pk_bf16_f32 v102, v104, v105
  s_waitcnt lgkmcnt(4)
  v_smfmac_f32_16x16x64_bf16 v[196:199], v[236:239], v[204:211], v242
  v_cvt_pk_bf16_f32 v103, v106, v107
  v_add_u32 v15, 256, v15
  v_smfmac_f32_16x16x64_bf16 v[200:203], v[236:239], v[212:219], v242
  ds_read2_b32 v[236:237], v241 offset0:32 offset1:34
  ds_read2_b32 v[238:239], v241 offset0:36 offset1:38
  ds_write_b64 v14, v[100:101]
  ds_write_b64 v14, v[102:103] offset:64
  s_waitcnt lgkmcnt(7)
  v_mfma_f32_16x16x32_bf16 v[180:183], v[60:63], v[220:223], v[180:183]
  ds_add_u32 v15, v12
  s_lshr_b32 s90, s86, 16
  v_mfma_f32_16x16x32_bf16 v[184:187], v[60:63], v[228:231], v[184:187]
  v_add_u32 v7, s90, v6
  v_lshrrev_b32 v8, 16, v21
  s_waitcnt lgkmcnt(7)
  v_mfma_f32_16x16x32_bf16 v[188:191], v[64:67], v[220:223], v[188:191]
  s_mov_b32 s17, s81
  s_add_u32 s4, s8, k2_bound3-k2_pcbase
  v_mfma_f32_16x16x32_bf16 v[192:195], v[64:67], v[228:231], v[192:195]
  s_addc_u32 s5, s9, 0
  s_lshl_b32 s13, s67, 1
  s_waitcnt lgkmcnt(6)
  v_mfma_f32_16x16x32_bf16 v[180:183], v[68:71], v[224:227], v[180:183]
  s_and_b32 s14, s85, 1
  s_min_u32 s10, s11, s67
  v_mfma_f32_16x16x32_bf16 v[184:187], v[68:71], v[232:235], v[184:187]
  s_sub_u32 s11, s11, s10
  s_sub_u32 s12, s67, s10
  s_waitcnt lgkmcnt(5)
  v_mfma_f32_16x16x32_bf16 v[188:191], v[72:75], v[224:227], v[188:191]
  s_cmp_eq_u32 s11, 0
  s_cselect_b64 vcc, -1, 0
  v_mfma_f32_16x16x32_bf16 v[192:195], v[72:75], v[232:235], v[192:195]
  s_sub_u32 s10, s10, 1
  s_waitcnt lgkmcnt(3)
  v_smfmac_f32_16x16x64_bf16 v[196:199], v[236:239], v[220:227], v242
  v_smfmac_f32_16x16x64_bf16 v[200:203], v[236:239], v[228:235], v242
  v_add_u32 v240, 256, v240
  v_add_u32 v241, 256, v241
  s_add_u32 s88, s92, 12288
  s_bitcmp1_b32 s85, 1
  buffer_load_dwordx4 v[204:207], v4, s[36:39], s88 offen offset:0
  buffer_load_dwordx4 v[212:215], v4, s[36:39], s88 offen offset:1024
  buffer_load_dwordx4 v[208:211], v4, s[36:39], s88 offen offset:2048
  buffer_load_dwordx4 v[216:219], v4, s[36:39], s88 offen offset:3072
  s_setprio 1
  s_cbranch_scc1 k2_rare
  s_setpc_b64 s[6:7]
k2_bound3:
  v_readfirstlane_b32 s88, v16
  v_maximum3_f32 v9, v9, v108, abs(v100)
  s_cmp_lt_u32 s88, 8
  v_maximum3_f32 v9, v9, v109, abs(v101)
  v_maximum3_f32 v9, v9, v110, abs(v102)
  v_maximum3_f32 v9, v9, v111, abs(v103)
  s_cbranch_scc1 k2_poll3
k2_polled3:
  s_waitcnt lgkmcnt(5)
  v_mfma_f32_16x16x32_bf16 v[180:183], v[60:63], v[204:207], v[180:183]
  v_maximum3_f32 v9, v9, v112, abs(v104)
  v_maximum3_f32 v9, v9, v113, abs(v105)
  v_mfma_f32_16x16x32_bf16 v[184:187], v[60:63], v[212:215], v[184:187]
  v_maximum3_f32 v9, v9, v114, abs(v106)
  v_maximum3_f32 v9, v9, v115, abs(v107)
  s_waitcnt lgkmcnt(4)
  v_mfma_f32_16x16x32_bf16 v[188:191], v[64:67], v[204:207], v[188:191]
  v_mul_f32 v100, v100, v76
  v_mul_f32 v101, v101, v77
  v_mfma_f32_16x16x32_bf16 v[192:195], v[64:67], v[212:215], v[192:195]
  v_mul_f32 v102, v102, v78
  v_mul_f32 v103, v103, v79
  s_waitcnt lgkmcnt(3)
  v_mfma_f32_16x16x32_bf16 v[180:183], v[68:71], v[208:211], v[180:183]
  v_mul_f32 v104, v104, v80
  v_mul_f32 v105, v105, v81
  v_mfma_f32_16x16x32_bf16 v[184:187], v[68:71], v[216:219], v[184:187]
  v_mul_f32 v106, v106, v82
  v_mul_f32 v107, v107, v83
  s_waitcnt lgkmcnt(2)
  v_mfma_f32_16x16x32_bf16 v[188:191], v[72:75], v[208:211], v[188:191]
  v_add_u32 v14, s21, v5
  v_cvt_pk_bf16_f32 v100, v100, v101
  v_mfma_f32_16x16x32_bf16 v[192:195], v[72:75], v[216:219], v[192:195]
  v_cvt_pk_bf16_f32 v101, v102, v103
  v_cvt_pk_bf16_f32 v102, v104, v105
  s_waitcnt lgkmcnt(0)
  v_smfmac_f32_16x16x64_bf16 v[196:199], v[236:239], v[204:211], v242
  v_cvt_pk_bf16_f32 v103, v106, v107
  v_add_u32 v15, 256, v15
  v_smfmac_f32_16x16x64_bf16 v[200:203], v[236:239], v[212:219], v242
  ds_write_b64 v14, v[100:101]
  ds_write_b64 v14, v[102:103] offset:64
  ds_add_u32 v15, v12
  v_lshrrev_b32 v8, 16, v22
  s_mov_b32 s17, s81
  s_add_u32 s4, s8, k2_bound4-k2_pcbase
  s_addc_u32 s5, s9, 0
  s_lshl_b32 s13, s68, 1
  s_and_b32 s14, s86, 1
  s_min_u32 s10, s11, s68
  s_sub_u32 s11, s11, s10
  s_sub_u32 s12, s68, s10
  s_cmp_eq_u32 s11, 0
  s_cselect_b64 vcc, -1, 0
  s_sub_u32 s10, s10, 1
  v_add_u32 v240, 128, v240
  v_add_u32 v241, 128, v241
  s_add_u32 s88, s92, 16384
  s_add_u32 s89, s92, 20480
  s_cmp_lt_u32 s26, 4
  buffer_load_dwordx4 v[204:207], v4, s[36:39], s88 offen offset:0
  buffer_load_dwordx4 v[212:215], v4, s[36:39], s88 offen offset:1024
  buffer_load_dwordx4 v[208:211], v4, s[36:39], s88 offen offset:2048
  buffer_load_dwordx4 v[216:219], v4, s[36:39], s88 offen offset:3072
  buffer_load_dwordx4 v[220:223], v4, s[36:39], s89 offen offset:0
  buffer_load_dwordx4 v[228:231], v4, s[36:39], s89 offen offset:1024
  buffer_load_dwordx4 v[224:227], v4, s[36:39], s89 offen offset:2048
  buffer_load_dwordx4 v[232:235], v4, s[36:39], s89 offen offset:3072
  s_setprio 0
  s_cbranch_scc1 k2_prio4
  s_setprio 1
k2_prio4:
  s_bitcmp1_b32 s86, 1
  s_nop 1
  s_cbranch_scc1 k2_rare
  s_setpc_b64 s[6:7]
k2_bound4:
  v_readfirstlane_b32 s88, v16
  v_maximum3_f32 v9, v9, v108, abs(v100)
  s_cmp_lt_u32 s88, 8
  v_maximum3_f32 v9, v9, v109, abs(v101)
  v_maximum3_f32 v9, v9, v110, abs(v102)
  v_maximum3_f32 v9, v9, v111, abs(v103)
  s_cbranch_scc1 k2_poll4
k2_polled4:
  s_waitcnt lgkmcnt(5)
  v_mfma_f32_16x16x32_bf16 v[180:183], v[60:63], v[204:207], v[180:183]
  v_maximum3_f32 v9, v9, v112, abs(v104)
  v_maximum3_f32 v9, v9, v113, abs(v105)
  v_mfma_f32_16x16x32_bf16 v[184:187], v[60:63], v[212:215], v[184:187]
  ds_read_b128 v[60:63], v240 offset:128
  v_maximum3_f32 v9, v9, v114, abs(v106)
  v_maximum3_f32 v9, v9, v115, abs(v107)
  s_waitcnt lgkmcnt(5)
  v_mfma_f32_16x16x32_bf16 v[188:191], v[64:67], v[204:207], v[188:191]
  v_mul_f32 v100, v100, v76
  v_mul_f32 v101, v101, v77
  v_mfma_f32_16x16x32_bf16 v[192:195], v[64:67], v[212:215], v[192:195]
  ds_read_b128 v[64:67], v240 offset:16768
  v_mul_f32 v102, v102, v78
  v_mul_f32 v103, v103, v79
  s_waitcnt lgkmcnt(5)
  v_mfma_f32_16x16x32_bf16 v[180:183], v[68:71], v[208:211], v[180:183]
  v_mul_f32 v104, v104, v80
  v_mul_f32 v105, v105, v81
  v_mfma_f32_16x16x32_bf16 v[184:187], v[68:71], v[216:219], v[184:187]
  ds_read_b128 v[68:71], v240 offset:192
  v_mul_f32 v106, v106, v82
  v_mul_f32 v107, v107, v83
  s_waitcnt lgkmcnt(5)
  v_mfma_f32_16x16x32_bf16 v[188:191], v[72:75], v[208:211], v[188:191]
  v_add_u32 v14, s22, v5
  v_cvt_pk_bf16_f32 v100, v100, v101
  v_mfma_f32_16x16x32_bf16 v[192:195], v[72:75], v[216:219], v[192:195]
  ds_read_b128 v[72:75], v240 offset:16832
  v_cvt_pk_bf16_f32 v101, v102, v103
  v_cvt_pk_bf16_f32 v102, v104, v105
  s_waitcnt lgkmcnt(4)
  v_smfmac_f32_16x16x64_bf16 v[196:199], v[236:239], v[204:211], v242
  v_cvt_pk_bf16_f32 v103, v106, v107
  v_add_u32 v15, 256, v15
  v_smfmac_f32_16x16x64_bf16 v[200:203], v[236:239], v[212:219], v242
  ds_read2_b32 v[236:237], v241 offset0:32 offset1:34
  ds_read2_b32 v[238:239], v241 offset0:36 offset1:38
  ds_write_b64 v14, v[100:101]
  ds_write_b64 v14, v[102:103] offset:64
  s_waitcnt lgkmcnt(7)
  v_mfma_f32_16x16x32_bf16 v[180:183], v[60:63], v[220:223], v[180:183]
  ds_add_u32 v15, v12
  v_mfma_f32_16x16x32_bf16 v[184:187], v[60:63], v[228:231], v[184:187]
  s_waitcnt lgkmcnt(7)
  v_mfma_f32_16x16x32_bf16 v[188:191], v[64:67], v[220:223], v[188:191]
  v_mfma_f32_16x16x32_bf16 v[192:195], v[64:67], v[228:231], v[192:195]
  s_waitcnt lgkmcnt(6)
  v_mfma_f32_16x16x32_bf16 v[180:183], v[68:71], v[224:227], v[180:183]
  v_mfma_f32_16x16x32_bf16 v[184:187], v[68:71], v[232:235], v[184:187]
  s_waitcnt lgkmcnt(5)
  v_mfma_f32_16x16x32_bf16 v[188:191], v[72:75], v[224:227], v[188:191]
  v_mfma_f32_16x16x32_bf16 v[192:195], v[72:75], v[232:235], v[192:195]
  s_waitcnt lgkmcnt(3)
  v_smfmac_f32_16x16x64_bf16 v[196:199], v[236:239], v[220:227], v242
  v_smfmac_f32_16x16x64_bf16 v[200:203], v[236:239], v[228:235], v242
  s_add_u32 s88, s92, 24576
  buffer_load_dwordx4 v[204:207], v4, s[36:39], s88 offen offset:0
  buffer_load_dwordx4 v[212:215], v4, s[36:39], s88 offen offset:1024
  buffer_load_dwordx4 v[208:211], v4, s[36:39], s88 offen offset:2048
  buffer_load_dwordx4 v[216:219], v4, s[36:39], s88 offen offset:3072
  s_add_u32 s88, s92, 28672
  buffer_load_dwordx4 v[220:223], v4, s[36:39], s88 offen offset:0
  buffer_load_dwordx4 v[228:231], v4, s[36:39], s88 offen offset:1024
  buffer_load_dwordx4 v[224:227], v4, s[36:39], s88 offen offset:2048
  buffer_load_dwordx4 v[232:235], v4, s[36:39], s88 offen offset:3072
  v_cmp_ngt_f32 vcc, 0x7b800000, v9
  v_and_b32 v14, 48, v1
  ds_read_b128 v[28:31], v14 offset:0
  ds_read_b128 v[32:35], v14 offset:64
  v_and_b32 v14, 16, v1
  v_lshrrev_b32 v38, 5, v1
  v_lshl_add_u32 v14, v38, 3, v14
  ds_read_b64 v[36:37], v14 offset:128
  v_add_u32 v240, 256, v240
  v_add_u32 v241, 256, v241
  v_mov_b32 v14, 2560
  s_cbranch_vccz k2_tail_ok
  ds_write_b32 v14, v12
k2_tail_ok:
  s_waitcnt lgkmcnt(0)
  v_add_u32 v28, v28, v10
  v_add_u32 v29, v29, v10
  v_add_u32 v30, v30, v10
  v_add_u32 v31, v31, v10
  v_add_u32 v32, v32, v10
  v_add_u32 v33, v33, v10
  v_add_u32 v34, v34, v10
  v_add_u32 v35, v35, v10
  v_add_u32 v36, v36, v10
  v_add_u32 v37, v37, v10
  s_mov_b32 s89, 0xbf317218
  s_barrier
  ds_read_b32 v16, v14
  ds_read2_b32 v[60:61], v241 offset0:0 offset1:2
  ds_read2_b32 v[62:63], v241 offset0:4 offset1:6
  ds_read2_b32 v[64:65], v241 offset0:32 offset1:34
  ds_read2_b32 v[66:67], v241 offset0:36 offset1:38
  ds_read_b128 v[68:71], v240 offset:0
  ds_read_b128 v[72:75], v240 offset:64
  ds_read_b128 v[236:239], v240 offset:128
  s_waitcnt lgkmcnt(7)
  v_readfirstlane_b32 s88, v16
  s_cmp_lg_u32 s88, 0
  s_waitcnt vmcnt(0)
  s_cbranch_scc1 k2_slow
  s_waitcnt lgkmcnt(5)
  v_smfmac_f32_16x16x64_bf16 v[196:199], v[60:63], v[204:211], v242
  v_smfmac_f32_16x16x64_bf16 v[200:203], v[60:63], v[212:219], v242
  ds_read_b128 v[60:63], v240 offset:192
  s_waitcnt lgkmcnt(4)
  v_smfmac_f32_16x16x64_bf16 v[196:199], v[64:67], v[220:227], v242
  v_smfmac_f32_16x16x64_bf16 v[200:203], v[64:67], v[228:235], v242
  ds_read_b128 v[64:67], v240 offset:16640
  s_waitcnt lgkmcnt(4)
  v_mfma_f32_16x16x32_bf16 v[180:183], v[68:71], v[204:207], v[180:183]
  v_mfma_f32_16x16x32_bf16 v[184:187], v[68:71], v[212:215], v[184:187]
  ds_read_b128 v[68:71], v240 offset:16704
  s_waitcnt lgkmcnt(4)
  v_mfma_f32_16x16x32_bf16 v[180:183], v[72:75], v[208:211], v[180:183]
  v_mfma_f32_16x16x32_bf16 v[184:187], v[72:75], v[216:219], v[184:187]
  ds_read_b128 v[72:75], v240 offset:16768
  s_waitcnt lgkmcnt(4)
  v_mfma_f32_16x16x32_bf16 v[180:183], v[236:239], v[220:223], v[180:183]
  v_permlane32_swap_b32 v196, v200
  v_permlane32_swap_b32 v197, v201
  v_permlane32_swap_b32 v198, v202
  v_permlane32_swap_b32 v199, v203
  v_mfma_f32_16x16x32_bf16 v[184:187], v[236:239], v[228:231], v[184:187]
  ds_read_b128 v[236:239], v240 offset:16832
  v_add_f32 v196, v196, v200
  v_add_f32 v197, v197, v201
  v_add_f32 v198, v198, v202
  v_add_f32 v199, v199, v203
  s_waitcnt lgkmcnt(4)
  v_mfma_f32_16x16x32_bf16 v[180:183], v[60:63], v[224:227], v[180:183]
  v_mul_f32 v196, s89, v196
  v_mul_f32 v197, s89, v197
  v_mul_f32 v198, s89, v198
  v_mul_f32 v199, s89, v199
  v_mfma_f32_16x16x32_bf16 v[184:187], v[60:63], v[232:235], v[184:187]
  s_nop 0
  v_permlane32_swap_b32 v196, v198
  v_permlane32_swap_b32 v197, v199
  v_cvt_pk_bf16_f32 v196, v196, v198
  s_waitcnt lgkmcnt(3)
  v_mfma_f32_16x16x32_bf16 v[188:191], v[64:67], v[204:207], v[188:191]
  v_cvt_pk_bf16_f32 v197, v197, v199
  buffer_store_dword v196, v36, s[40:43], 0 offen sc1
  buffer_store_dword v197, v37, s[40:43], 0 offen sc1
  v_mfma_f32_16x16x32_bf16 v[192:195], v[64:67], v[212:215], v[192:195]
  s_waitcnt lgkmcnt(2)
  v_mfma_f32_16x16x32_bf16 v[188:191], v[68:71], v[208:211], v[188:191]
  v_mfma_f32_16x16x32_bf16 v[192:195], v[68:71], v[216:219], v[192:195]
  s_waitcnt lgkmcnt(1)
  v_mfma_f32_16x16x32_bf16 v[188:191], v[72:75], v[220:223], v[188:191]
  v_mul_f32 v180, s89, v180
  v_mul_f32 v184, s89, v184
  v_cvt_pk_bf16_f32 v180, v180, v184
  v_mul_f32 v181, s89, v181
  v_mfma_f32_16x16x32_bf16 v[192:195], v[72:75], v[228:231], v[192:195]
  v_mul_f32 v185, s89, v185
  v_cvt_pk_bf16_f32 v181, v181, v185
  buffer_store_dword v180, v28, s[40:43], 0 offen sc1
  v_mul_f32 v182, s89, v182
  s_waitcnt lgkmcnt(0)
  v_mfma_f32_16x16x32_bf16 v[188:191], v[236:239], v[224:227], v[188:191]
  v_mul_f32 v186, s89, v186
  v_cvt_pk_bf16_f32 v182, v182, v186
  buffer_store_dword v181, v29, s[40:43], 0 offen sc1
  v_mul_f32 v183, s89, v183
  v_mfma_f32_16x16x32_bf16 v[192:195], v[236:239], v[232:235], v[192:195]
  v_mul_f32 v187, s89, v187
  v_cvt_pk_bf16_f32 v183, v183, v187
  buffer_store_dword v182, v30, s[40:43], 0 offen sc1
  buffer_store_dword v183, v31, s[40:43], 0 offen sc1
  s_nop 7
  v_mul_f32 v188, s89, v188
  v_mul_f32 v192, s89, v192
  v_cvt_pk_bf16_f32 v188, v188, v192
  v_mul_f32 v189, s89, v189
  v_mul_f32 v193, s89, v193
  v_cvt_pk_bf16_f32 v189, v189, v193
  buffer_store_dword v188, v32, s[40:43], 0 offen sc1
  v_mul_f32 v190, s89, v190
  v_mul_f32 v194, s89, v194
  v_cvt_pk_bf16_f32 v190, v190, v194
  buffer_store_dword v189, v33, s[40:43], 0 offen sc1
  v_mul_f32 v191, s89, v191
  v_mul_f32 v195, s89, v195
  v_cvt_pk_bf16_f32 v191, v191, v195
  buffer_store_dword v190, v34, s[40:43], 0 offen sc1
  buffer_store_dword v191, v35, s[40:43], 0 offen sc1
k2_end:
  s_endpgm
k2_rare:
  v_sub_u32 v14, v8, s13
  v_min_i32 v14, 0, v14
  v_cvt_f32_i32 v14, v14
  s_cmp_eq_u32 s13, 0
  s_cselect_b32 s88, 8, 4
  s_cmp_ge_u32 s13, 4
  s_cselect_b32 s88, 12, s88
  v_exp_f32 v108, v84
  v_mul_f32 v100, v14, v84
  v_exp_f32 v109, v85
  v_mul_f32 v101, v14, v85
  v_exp_f32 v110, v86
  v_mul_f32 v102, v14, v86
  v_exp_f32 v111, v87
  v_mul_f32 v103, v14, v87
  v_exp_f32 v112, v88
  v_mul_f32 v104, v14, v88
  v_exp_f32 v113, v89
  v_mul_f32 v105, v14, v89
  v_exp_f32 v114, v90
  v_mul_f32 v106, v14, v90
  v_exp_f32 v115, v91
  v_mul_f32 v107, v14, v91
  s_cbranch_scc1 k2_rare_long
  s_waitcnt vmcnt(0)
k2_rare_long:
  s_sub_u32 s6, s6, s88
  s_subb_u32 s7, s7, 0
  v_pk_add_f32 v[108:109], v[108:109], 1.0 op_sel_hi:[1,0]
  v_pk_add_f32 v[110:111], v[110:111], 1.0 op_sel_hi:[1,0]
  v_pk_add_f32 v[112:113], v[112:113], 1.0 op_sel_hi:[1,0]
  v_pk_add_f32 v[114:115], v[114:115], 1.0 op_sel_hi:[1,0]
  s_setpc_b64 s[6:7]
k2_firstg0:
  v_mfma_f32_32x32x8bf16_1k v[44:59], v[24:25], v[154:155], v[84:99]
  v_exp_f32 v60, v28
  v_exp_f32 v61, v29
  v_exp_f32 v62, v30
  v_exp_f32 v63, v31
  v_exp_f32 v64, v32
  s_waitcnt vmcnt(10) lgkmcnt(0)
  v_smfmac_f32_32x32x32_bf16 v[44:59], v[172:175], v[124:131], v178
  buffer_load_dwordx4 v[116:119], v148, s[28:31], s16 offen offset:0
  buffer_load_dwordx4 v[120:123], v148, s[28:31], s16 offen offset:64
  ds_read_b128 v[152:155], v3 offset:0
  v_exp_f32 v65, v33
  v_exp_f32 v66, v34
  v_exp_f32 v67, v35
  v_pk_fma_f32 v[100:101], v[100:101], v[60:61], v[100:101]
  v_pk_fma_f32 v[102:103], v[102:103], v[62:63], v[102:103]
  v_pk_fma_f32 v[104:105], v[104:105], v[64:65], v[104:105]
  v_pk_fma_f32 v[106:107], v[106:107], v[66:67], v[106:107]
  v_pk_fma_f32 v[100:101], v[28:29], v[108:109], v[100:101]
  v_pk_fma_f32 v[102:103], v[30:31], v[110:111], v[102:103]
  v_pk_fma_f32 v[104:105], v[32:33], v[112:113], v[104:105]
  v_pk_fma_f32 v[106:107], v[34:35], v[114:115], v[106:107]
  v_exp_f32 v68, v36
  v_exp_f32 v69, v37
  v_exp_f32 v70, v38
  v_exp_f32 v71, v39
  v_exp_f32 v72, v40
  v_exp_f32 v73, v41
  v_exp_f32 v74, v42
  v_exp_f32 v75, v43
  v_pk_fma_f32 v[108:109], v[108:109], v[60:61], v[108:109]
  v_pk_fma_f32 v[110:111], v[110:111], v[62:63], v[110:111]
  v_pk_fma_f32 v[112:113], v[112:113], v[64:65], v[112:113]
  v_pk_fma_f32 v[114:115], v[114:115], v[66:67], v[114:115]
  v_pk_fma_f32 v[100:101], v[100:101], v[68:69], v[100:101]
  v_pk_fma_f32 v[102:103], v[102:103], v[70:71], v[102:103]
  v_pk_fma_f32 v[104:105], v[104:105], v[72:73], v[104:105]
  v_pk_fma_f32 v[106:107], v[106:107], v[74:75], v[106:107]
  v_pk_fma_f32 v[100:101], v[36:37], v[108:109], v[100:101]
  v_pk_fma_f32 v[102:103], v[38:39], v[110:111], v[102:103]
  v_pk_fma_f32 v[104:105], v[40:41], v[112:113], v[104:105]
  v_pk_fma_f32 v[106:107], v[42:43], v[114:115], v[106:107]
  v_pk_fma_f32 v[108:109], v[108:109], v[68:69], v[108:109]
  s_sub_u32 s10, s10, 1
  v_pk_fma_f32 v[110:111], v[110:111], v[70:71], v[110:111]
  v_pk_fma_f32 v[112:113], v[112:113], v[72:73], v[112:113]
  v_pk_fma_f32 v[114:115], v[114:115], v[74:75], v[114:115]
  s_cbranch_scc0 k2_rel0_1
  s_branch k2_event1
k2_firstg1:
  v_mfma_f32_32x32x8bf16_1k v[28:43], v[24:25], v[158:159], v[84:99]
  v_exp_f32 v60, v44
  v_exp_f32 v61, v45
  v_exp_f32 v62, v46
  v_exp_f32 v63, v47
  v_exp_f32 v64, v48
  s_waitcnt vmcnt(10) lgkmcnt(0)
  v_smfmac_f32_32x32x32_bf16 v[28:43], v[172:175], v[132:139], v178
  buffer_load_dwordx4 v[124:127], v152, s[28:31], s16 offen offset:0
  buffer_load_dwordx4 v[128:131], v152, s[28:31], s16 offen offset:64
  ds_read_b128 v[156:159], v3 offset:1024
  v_exp_f32 v65, v49
  v_exp_f32 v66, v50
  v_exp_f32 v67, v51
  v_pk_fma_f32 v[100:101], v[100:101], v[60:61], v[100:101]
  v_pk_fma_f32 v[102:103], v[102:103], v[62:63], v[102:103]
  v_pk_fma_f32 v[104:105], v[104:105], v[64:65], v[104:105]
  v_pk_fma_f32 v[106:107], v[106:107], v[66:67], v[106:107]
  v_pk_fma_f32 v[100:101], v[44:45], v[108:109], v[100:101]
  v_pk_fma_f32 v[102:103], v[46:47], v[110:111], v[102:103]
  v_pk_fma_f32 v[104:105], v[48:49], v[112:113], v[104:105]
  v_pk_fma_f32 v[106:107], v[50:51], v[114:115], v[106:107]
  v_exp_f32 v68, v52
  v_exp_f32 v69, v53
  v_exp_f32 v70, v54
  v_exp_f32 v71, v55
  v_exp_f32 v72, v56
  v_exp_f32 v73, v57
  v_exp_f32 v74, v58
  v_exp_f32 v75, v59
  v_pk_fma_f32 v[108:109], v[108:109], v[60:61], v[108:109]
  v_pk_fma_f32 v[110:111], v[110:111], v[62:63], v[110:111]
  v_pk_fma_f32 v[112:113], v[112:113], v[64:65], v[112:113]
  v_pk_fma_f32 v[114:115], v[114:115], v[66:67], v[114:115]
  v_pk_fma_f32 v[100:101], v[100:101], v[68:69], v[100:101]
  v_pk_fma_f32 v[102:103], v[102:103], v[70:71], v[102:103]
  v_pk_fma_f32 v[104:105], v[104:105], v[72:73], v[104:105]
  v_pk_fma_f32 v[106:107], v[106:107], v[74:75], v[106:107]
  v_pk_fma_f32 v[100:101], v[52:53], v[108:109], v[100:101]
  v_pk_fma_f32 v[102:103], v[54:55], v[110:111], v[102:103]
  v_pk_fma_f32 v[104:105], v[56:57], v[112:113], v[104:105]
  v_pk_fma_f32 v[106:107], v[58:59], v[114:115], v[106:107]
  v_pk_fma_f32 v[108:109], v[108:109], v[68:69], v[108:109]
  s_sub_u32 s10, s10, 1
  v_pk_fma_f32 v[110:111], v[110:111], v[70:71], v[110:111]
  v_pk_fma_f32 v[112:113], v[112:113], v[72:73], v[112:113]
  v_pk_fma_f32 v[114:115], v[114:115], v[74:75], v[114:115]
  s_cbranch_scc0 k2_rel0_2
  s_branch k2_event2
k2_firstg2:
  v_mfma_f32_32x32x8bf16_1k v[44:59], v[24:25], v[162:163], v[84:99]
  v_exp_f32 v60, v28
  v_exp_f32 v61, v29
  v_exp_f32 v62, v30
  v_exp_f32 v63, v31
  v_exp_f32 v64, v32
  s_waitcnt vmcnt(10) lgkmcnt(0)
  v_smfmac_f32_32x32x32_bf16 v[44:59], v[172:175], v[140:147], v178
  buffer_load_dwordx4 v[132:135], v156, s[28:31], s16 offen offset:0
  buffer_load_dwordx4 v[136:139], v156, s[28:31], s16 offen offset:64
  ds_read_b128 v[160:163], v3 offset:2048
  v_exp_f32 v65, v33
  v_exp_f32 v66, v34
  v_exp_f32 v67, v35
  v_pk_fma_f32 v[100:101], v[100:101], v[60:61], v[100:101]
  v_pk_fma_f32 v[102:103], v[102:103], v[62:63], v[102:103]
  v_pk_fma_f32 v[104:105], v[104:105], v[64:65], v[104:105]
  v_pk_fma_f32 v[106:107], v[106:107], v[66:67], v[106:107]
  v_pk_fma_f32 v[100:101], v[28:29], v[108:109], v[100:101]
  v_pk_fma_f32 v[102:103], v[30:31], v[110:111], v[102:103]
  v_pk_fma_f32 v[104:105], v[32:33], v[112:113], v[104:105]
  v_pk_fma_f32 v[106:107], v[34:35], v[114:115], v[106:107]
  v_exp_f32 v68, v36
  v_exp_f32 v69, v37
  v_exp_f32 v70, v38
  v_exp_f32 v71, v39
  v_exp_f32 v72, v40
  v_exp_f32 v73, v41
  v_exp_f32 v74, v42
  v_exp_f32 v75, v43
  v_pk_fma_f32 v[108:109], v[108:109], v[60:61], v[108:109]
  v_pk_fma_f32 v[110:111], v[110:111], v[62:63], v[110:111]
  v_pk_fma_f32 v[112:113], v[112:113], v[64:65], v[112:113]
  v_pk_fma_f32 v[114:115], v[114:115], v[66:67], v[114:115]
  v_pk_fma_f32 v[100:101], v[100:101], v[68:69], v[100:101]
  v_pk_fma_f32 v[102:103], v[102:103], v[70:71], v[102:103]
  v_pk_fma_f32 v[104:105], v[104:105], v[72:73], v[104:105]
  v_pk_fma_f32 v[106:107], v[106:107], v[74:75], v[106:107]
  v_pk_fma_f32 v[100:101], v[36:37], v[108:109], v[100:101]
  v_pk_fma_f32 v[102:103], v[38:39], v[110:111], v[102:103]
  v_pk_fma_f32 v[104:105], v[40:41], v[112:113], v[104:105]
  v_pk_fma_f32 v[106:107], v[42:43], v[114:115], v[106:107]
  v_pk_fma_f32 v[108:109], v[108:109], v[68:69], v[108:109]
  s_sub_u32 s10, s10, 1
  v_pk_fma_f32 v[110:111], v[110:111], v[70:71], v[110:111]
  v_pk_fma_f32 v[112:113], v[112:113], v[72:73], v[112:113]
  v_pk_fma_f32 v[114:115], v[114:115], v[74:75], v[114:115]
  s_cbranch_scc0 k2_rel0_3
  s_branch k2_event3
k2_firstg3:
  v_mfma_f32_32x32x8bf16_1k v[28:43], v[24:25], v[150:151], v[84:99]
  v_exp_f32 v60, v44
  v_exp_f32 v61, v45
  v_exp_f32 v62, v46
  v_exp_f32 v63, v47
  v_exp_f32 v64, v48
  s_waitcnt vmcnt(10) lgkmcnt(0)
  v_smfmac_f32_32x32x32_bf16 v[28:43], v[172:175], v[116:123], v178
  buffer_load_dwordx4 v[140:143], v160, s[28:31], s16 offen offset:0
  buffer_load_dwordx4 v[144:147], v160, s[28:31], s16 offen offset:64
  ds_read_b128 v[148:151], v3 offset:3072
  v_exp_f32 v65, v49
  v_exp_f32 v66, v50
  v_exp_f32 v67, v51
  v_pk_fma_f32 v[100:101], v[100:101], v[60:61], v[100:101]
  v_pk_fma_f32 v[102:103], v[102:103], v[62:63], v[102:103]
  v_pk_fma_f32 v[104:105], v[104:105], v[64:65], v[104:105]
  v_pk_fma_f32 v[106:107], v[106:107], v[66:67], v[106:107]
  v_pk_fma_f32 v[100:101], v[44:45], v[108:109], v[100:101]
  v_pk_fma_f32 v[102:103], v[46:47], v[110:111], v[102:103]
  v_pk_fma_f32 v[104:105], v[48:49], v[112:113], v[104:105]
  v_pk_fma_f32 v[106:107], v[50:51], v[114:115], v[106:107]
  v_add_u32 v3, 4096, v3
  v_exp_f32 v68, v52
  v_exp_f32 v69, v53
  v_exp_f32 v70, v54
  v_exp_f32 v71, v55
  v_exp_f32 v72, v56
  v_exp_f32 v73, v57
  v_exp_f32 v74, v58
  v_exp_f32 v75, v59
  v_pk_fma_f32 v[108:109], v[108:109], v[60:61], v[108:109]
  v_pk_fma_f32 v[110:111], v[110:111], v[62:63], v[110:111]
  v_pk_fma_f32 v[112:113], v[112:113], v[64:65], v[112:113]
  v_pk_fma_f32 v[114:115], v[114:115], v[66:67], v[114:115]
  v_pk_fma_f32 v[100:101], v[100:101], v[68:69], v[100:101]
  v_pk_fma_f32 v[102:103], v[102:103], v[70:71], v[102:103]
  v_pk_fma_f32 v[104:105], v[104:105], v[72:73], v[104:105]
  v_pk_fma_f32 v[106:107], v[106:107], v[74:75], v[106:107]
  v_pk_fma_f32 v[100:101], v[52:53], v[108:109], v[100:101]
  v_pk_fma_f32 v[102:103], v[54:55], v[110:111], v[102:103]
  v_pk_fma_f32 v[104:105], v[56:57], v[112:113], v[104:105]
  v_pk_fma_f32 v[106:107], v[58:59], v[114:115], v[106:107]
  v_pk_fma_f32 v[108:109], v[108:109], v[68:69], v[108:109]
  s_sub_u32 s10, s10, 1
  v_pk_fma_f32 v[110:111], v[110:111], v[70:71], v[110:111]
  v_pk_fma_f32 v[112:113], v[112:113], v[72:73], v[112:113]
  v_pk_fma_f32 v[114:115], v[114:115], v[74:75], v[114:115]
  s_cbranch_scc0 k2_rel0_0
  s_branch k2_event0
k2_short_first:
  ds_read_b128 v[148:151], v3 offset:0
  s_waitcnt lgkmcnt(0)
  buffer_load_dwordx4 v[116:119], v148, s[28:31], s16 offen offset:0
  buffer_load_dwordx4 v[120:123], v148, s[28:31], s16 offen offset:64
  s_sub_u32 s11, s11, 1
  s_cmp_lg_u32 s11, 0
  s_cbranch_scc1 k2_pro_0
  s_mov_b32 m0, s15
  s_add_u32 s15, s15, 1
  s_movrels_b32 s88, s70
  s_movrels_b32 s11, s64
  s_movrels_b32 s16, s76
  s_add_u32 s88, s88, 4294966272
  s_add_u32 s11, s11, 1
  v_add_u32 v3, s88, v4
k2_pro_0:
  ds_read_b128 v[152:155], v3 offset:1024
  s_waitcnt lgkmcnt(0)
  buffer_load_dwordx4 v[124:127], v152, s[28:31], s16 offen offset:0
  buffer_load_dwordx4 v[128:131], v152, s[28:31], s16 offen offset:64
  s_sub_u32 s11, s11, 1
  s_cmp_lg_u32 s11, 0
  s_cbranch_scc1 k2_pro_1
  s_mov_b32 m0, s15
  s_add_u32 s15, s15, 1
  s_movrels_b32 s88, s70
  s_movrels_b32 s11, s64
  s_movrels_b32 s16, s76
  s_add_u32 s88, s88, 4294965248
  s_add_u32 s11, s11, 1
  v_add_u32 v3, s88, v4
k2_pro_1:
  ds_read_b128 v[156:159], v3 offset:2048
  s_waitcnt lgkmcnt(0)
  buffer_load_dwordx4 v[132:135], v156, s[28:31], s16 offen offset:0
  buffer_load_dwordx4 v[136:139], v156, s[28:31], s16 offen offset:64
  s_sub_u32 s11, s11, 1
  s_cmp_lg_u32 s11, 0
  s_cbranch_scc1 k2_pro_2
  s_mov_b32 m0, s15
  s_add_u32 s15, s15, 1
  s_movrels_b32 s88, s70
  s_movrels_b32 s11, s64
  s_movrels_b32 s16, s76
  s_add_u32 s88, s88, 4294964224
  s_add_u32 s11, s11, 1
  v_add_u32 v3, s88, v4
k2_pro_2:
  ds_read_b128 v[160:163], v3 offset:3072
  s_waitcnt lgkmcnt(0)
  buffer_load_dwordx4 v[140:143], v160, s[28:31], s16 offen offset:0
  buffer_load_dwordx4 v[144:147], v160, s[28:31], s16 offen offset:64
  v_add_u32 v3, 4096, v3
  s_sub_u32 s11, s11, 1
  s_cmp_lg_u32 s11, 0
  s_cbranch_scc1 k2_pro_3
  s_mov_b32 m0, s15
  s_add_u32 s15, s15, 1
  s_movrels_b32 s88, s70
  s_movrels_b32 s11, s64
  s_movrels_b32 s16, s76
  s_add_u32 s88, s88, 0
  s_add_u32 s11, s11, 1
  v_add_u32 v3, s88, v4
k2_pro_3:
  s_branch k2_primed
k2_poll1:
  s_mov_b32 s89, 0
k2_pollagain1:
  ds_read_b32 v16, v15
  s_add_u32 s89, s89, 1
  s_waitcnt lgkmcnt(0)
  v_readfirstlane_b32 s88, v16
  s_cmp_ge_u32 s88, 8
  s_cselect_b32 s89, 0x200000, s89
  s_cmp_lt_u32 s89, 0x200000
  s_cbranch_scc1 k2_pollagain1
  ds_read_b128 v[60:63], v240 offset:0
  ds_read_b128 v[64:67], v240 offset:16640
  ds_read_b128 v[68:71], v240 offset:64
  ds_read_b128 v[72:75], v240 offset:16704
  ds_read2_b32 v[236:237], v241 offset0:0 offset1:2
  ds_read2_b32 v[238:239], v241 offset0:4 offset1:6
  s_branch k2_polled1
k2_poll2:
  s_mov_b32 s89, 0
k2_pollagain2:
  ds_read_b32 v16, v15
  s_add_u32 s89, s89, 1
  s_waitcnt lgkmcnt(0)
  v_readfirstlane_b32 s88, v16
  s_cmp_ge_u32 s88, 8
  s_cselect_b32 s89, 0x200000, s89
  s_cmp_lt_u32 s89, 0x200000
  s_cbranch_scc1 k2_pollagain2
  ds_read_b128 v[60:63], v240 offset:0
  ds_read_b128 v[64:67], v240 offset:16640
  ds_read_b128 v[68:71], v240 offset:64
  ds_read_b128 v[72:75], v240 offset:16704
  ds_read2_b32 v[236:237], v241 offset0:0 offset1:2
  ds_read2_b32 v[238:239], v241 offset0:4 offset1:6
  s_branch k2_polled2
k2_poll3:
  s_mov_b32 s89, 0
k2_pollagain3:
  ds_read_b32 v16, v15
  s_add_u32 s89, s89, 1
  s_waitcnt lgkmcnt(0)
  v_readfirstlane_b32 s88, v16
  s_cmp_ge_u32 s88, 8
  s_cselect_b32 s89, 0x200000, s89
  s_cmp_lt_u32 s89, 0x200000
  s_cbranch_scc1 k2_pollagain3
  ds_read_b128 v[60:63], v240 offset:0
  ds_read_b128 v[64:67], v240 offset:16640
  ds_read_b128 v[68:71], v240 offset:64
  ds_read_b128 v[72:75], v240 offset:16704
  ds_read2_b32 v[236:237], v241 offset0:0 offset1:2
  ds_read2_b32 v[238:239], v241 offset0:4 offset1:6
  s_branch k2_polled3
k2_poll4:
  s_mov_b32 s89, 0
k2_pollagain4:
  ds_read_b32 v16, v15
  s_add_u32 s89, s89, 1
  s_waitcnt lgkmcnt(0)
  v_readfirstlane_b32 s88, v16
  s_cmp_ge_u32 s88, 8
  s_cselect_b32 s89, 0x200000, s89
  s_cmp_lt_u32 s89, 0x200000
  s_cbranch_scc1 k2_pollagain4
  ds_read_b128 v[60:63], v240 offset:0
  ds_read_b128 v[64:67], v240 offset:16640
  ds_read_b128 v[68:71], v240 offset:64
  ds_read_b128 v[72:75], v240 offset:16704
  ds_read2_b32 v[236:237], v241 offset0:0 offset1:2
  ds_read2_b32 v[238:239], v241 offset0:4 offset1:6
  s_branch k2_polled4
k2_slow_static:
  s_waitcnt vmcnt(0)
  s_lshr_b32 s88, s2, 3
  s_mul_i32 s88, s88, 313
  s_and_b32 s89, s2, 7
  s_mul_i32 s89, s89, 40
  s_add_u32 s90, s88, 313
  s_min_u32 s90, s90, 10000
  s_add_u32 s88, s88, s89
  s_add_u32 s89, s88, 40
  s_min_u32 s90, s90, s89
  v_add_u32 v60, s88, v1
  v_cmp_gt_u32 vcc, s90, v60
  v_mov_b32 v61, 10000
  v_lshlrev_b32 v62, 2, v1
  v_cndmask_b32 v60, v61, v60, vcc
  v_lshlrev_b32 v60, 9, v60
  ds_write_b32 v62, v60 offset:0
  s_branch k2_slow_go
k2_slow:
  v_subrev_u32 v240, 768, v240
  v_subrev_u32 v241, 768, v241
k2_slow_go:
  s_setprio 0
  s_waitcnt vmcnt(0) lgkmcnt(0)
  s_load_dwordx16 s[4:19], s[0:1], 0
  s_waitcnt lgkmcnt(0)
  s_barrier
  s_lshr_b32 s56, s2, 3
  s_mul_i32 s56, s56, 313
  v_lshlrev_b32 v28, 2, v1
  v_lshlrev_b32 v60, 2, v0
  v_lshlrev_b32 v61, 4, v0
  v_mov_b32 v62, -1
  v_mov_b32 v64, 0
  v_mov_b32 v65, 0
  v_mov_b32 v66, 0
  v_mov_b32 v67, 0
  v_cmp_gt_u32 vcc, 320, v0
  s_nop 1
  v_cndmask_b32 v62, 0, v62, vcc
  ds_write_b32 v60, v62 offset:1024
  v_add_u32 v61, 4096, v61
  ds_write_b128 v61, v[64:67] offset:0
  ds_write_b128 v61, v[64:67] offset:8192
  ds_write_b128 v61, v[64:67] offset:16384
  ds_write_b128 v61, v[64:67] offset:24576
  ds_write_b128 v61, v[64:67] offset:32768
  ds_write_b128 v61, v[64:67] offset:40960
  ds_write_b128 v61, v[64:67] offset:49152
  ds_write_b128 v61, v[64:67] offset:57344
  v_add_u32 v61, 65536, v61
  ds_write_b128 v61, v[64:67] offset:0
  ds_write_b128 v61, v[64:67] offset:8192
  s_mov_b32 s44, s12
  s_mov_b32 s45, s13
  s_mov_b32 s46, 525312
  s_mov_b32 s47, 0x00020000
  v_lshrrev_b32 v60, 3, v1
  v_and_b32 v62, 7, v1
  s_mov_b32 s88, 1310720
  v_mul_lo_u32 v29, v60, s88
  v_lshl_add_u32 v29, v62, 4, v29
  v_lshlrev_b32 v60, 7, v60
  v_lshl_add_u32 v60, v62, 2, v60
  s_mov_b32 s88, 524288
  buffer_load_ushort v44, v60, s[44:47], s88 offen offset:0
  buffer_load_ushort v45, v60, s[44:47], s88 offen offset:32
  buffer_load_ushort v46, v60, s[44:47], s88 offen offset:64
  buffer_load_ushort v47, v60, s[44:47], s88 offen offset:96
  buffer_load_ushort v48, v60, s[44:47], s88 offen offset:2
  buffer_load_ushort v49, v60, s[44:47], s88 offen offset:34
  buffer_load_ushort v50, v60, s[44:47], s88 offen offset:66
  buffer_load_ushort v51, v60, s[44:47], s88 offen offset:98
  s_waitcnt lgkmcnt(0)
  s_barrier
  ds_read_b32 v60, v28 offset:0
  s_waitcnt lgkmcnt(0)
  v_lshrrev_b32 v60, 9, v60
  v_cmp_gt_u32 vcc, 10000, v60
  v_cmp_gt_u32 s[96:97], 40, v1
  v_subrev_u32 v60, s56, v60
  v_lshlrev_b32 v60, 2, v60
  s_and_b64 exec, vcc, s[96:97]
  ds_write_b32 v60, v1 offset:1024
  s_mov_b64 exec, -1
  s_mov_b32 s88, 0xbfb8aa3b
  s_waitcnt vmcnt(0)
  v_lshlrev_b32 v44, 16, v44
  v_mul_f32 v44, s88, v44
  v_lshlrev_b32 v45, 16, v45
  v_mul_f32 v45, s88, v45
  v_lshlrev_b32 v46, 16, v46
  v_mul_f32 v46, s88, v46
  v_lshlrev_b32 v47, 16, v47
  v_mul_f32 v47, s88, v47
  v_lshlrev_b32 v48, 16, v48
  v_mul_f32 v48, s88, v48
  v_lshlrev_b32 v49, 16, v49
  v_mul_f32 v49, s88, v49
  v_lshlrev_b32 v50, 16, v50
  v_mul_f32 v50, s88, v50
  v_lshlrev_b32 v51, 16, v51
  v_mul_f32 v51, s88, v51
  s_mov_b32 s44, s10
  s_mov_b32 s45, s11
  s_mov_b32 s46, 640000
  s_mov_b32 s47, 0x00020000
  s_mov_b32 s48, s8
  s_mov_b32 s49, s9
  s_mov_b32 s50, 640000
  s_mov_b32 s51, 0x00020000
  s_mov_b32 s52, s6
  s_mov_b32 s53, s7
  s_mov_b32 s54, 320000
  s_mov_b32 s55, 0x00020000
  s_lshl_b32 s57, s26, 6
  v_lshlrev_b32 v61, 1, v1
  s_waitcnt lgkmcnt(0)
  s_barrier
k2_slow_scan:
  s_lshl_b32 s88, s57, 2
  s_lshl_b32 s89, s57, 1
  buffer_load_dword v30, v28, s[44:47], s88 offen
  buffer_load_dword v31, v28, s[48:51], s88 offen
  buffer_load_ushort v32, v61, s[52:55], s89 offen
  s_waitcnt vmcnt(0)
  v_subrev_u32 v33, s56, v30
  v_min_u32 v33, 319, v33
  v_lshlrev_b32 v33, 2, v33
  ds_read_b32 v33, v33 offset:1024
  v_lshlrev_b32 v32, 16, v32
  s_waitcnt lgkmcnt(0)
  v_cmp_le_i32 s[96:97], 0, v33
  s_nop 3
k2_slow_edge:
  s_cmp_eq_u64 s[96:97], 0
  s_cbranch_scc1 k2_slow_next
  s_ff1_i32_b64 s88, s[96:97]
  s_bitset0_b64 s[96:97], s88
  v_readlane_b32 s89, v31, s88
  v_readlane_b32 s90, v30, s88
  v_readlane_b32 s91, v32, s88
  v_readlane_b32 s88, v33, s88
  s_lshl_b32 s89, s89, 7
  s_lshl_b32 s90, s90, 7
  s_nop 3
  buffer_load_dwordx4 v[116:119], v29, s[28:31], s89 offen
  buffer_load_dwordx4 v[120:123], v29, s[32:35], s90 offen
  s_lshl_b32 s89, s88, 11
  s_add_u32 s89, s89, 4096
  v_add_u32 v34, s89, v28
  s_lshl_b32 s88, s88, 2
  v_mov_b32 v62, s88
  s_mov_b64 exec, 1
  ds_add_u32 v62, v12 offset:2304
  s_mov_b64 exec, -1
  s_waitcnt vmcnt(0)
  v_lshlrev_b32 v64, 16, v116
  v_lshlrev_b32 v65, 16, v120
  v_fma_f32 v65, s91, v44, v65
  v_add_f32 v64, v64, v65
  v_exp_f32 v65, v64
  s_nop 0
  v_add_f32 v65, 1.0, v65
  v_rcp_f32 v65, v65
  s_nop 0
  v_mul_f32 v124, v64, v65
  ds_add_f32 v34, v124 offset:0
  v_and_b32 v64, 0xffff0000, v116
  v_and_b32 v65, 0xffff0000, v120
  v_fma_f32 v65, s91, v45, v65
  v_add_f32 v64, v64, v65
  v_exp_f32 v65, v64
  s_nop 0
  v_add_f32 v65, 1.0, v65
  v_rcp_f32 v65, v65
  s_nop 0
  v_mul_f32 v125, v64, v65
  ds_add_f32 v34, v125 offset:256
  v_lshlrev_b32 v64, 16, v117
  v_lshlrev_b32 v65, 16, v121
  v_fma_f32 v65, s91, v46, v65
  v_add_f32 v64, v64, v65
  v_exp_f32 v65, v64
  s_nop 0
  v_add_f32 v65, 1.0, v65
  v_rcp_f32 v65, v65
  s_nop 0
  v_mul_f32 v126, v64, v65
  ds_add_f32 v34, v126 offset:512
  v_and_b32 v64, 0xffff0000, v117
  v_and_b32 v65, 0xffff0000, v121
  v_fma_f32 v65, s91, v47, v65
  v_add_f32 v64, v64, v65
  v_exp_f32 v65, v64
  s_nop 0
  v_add_f32 v65, 1.0, v65
  v_rcp_f32 v65, v65
  s_nop 0
  v_mul_f32 v127, v64, v65
  ds_add_f32 v34, v127 offset:768
  v_lshlrev_b32 v64, 16, v118
  v_lshlrev_b32 v65, 16, v122
  v_fma_f32 v65, s91, v48, v65
  v_add_f32 v64, v64, v65
  v_exp_f32 v65, v64
  s_nop 0
  v_add_f32 v65, 1.0, v65
  v_rcp_f32 v65, v65
  s_nop 0
  v_mul_f32 v128, v64, v65
  ds_add_f32 v34, v128 offset:1024
  v_and_b32 v64, 0xffff0000, v118
  v_and_b32 v65, 0xffff0000, v122
  v_fma_f32 v65, s91, v49, v65
  v_add_f32 v64, v64, v65
  v_exp_f32 v65, v64
  s_nop 0
  v_add_f32 v65, 1.0, v65
  v_rcp_f32 v65, v65
  s_nop 0
  v_mul_f32 v129, v64, v65
  ds_add_f32 v34, v129 offset:1280
  v_lshlrev_b32 v64, 16, v119
  v_lshlrev_b32 v65, 16, v123
  v_fma_f32 v65, s91, v50, v65
  v_add_f32 v64, v64, v65
  v_exp_f32 v65, v64
  s_nop 0
  v_add_f32 v65, 1.0, v65
  v_rcp_f32 v65, v65
  s_nop 0
  v_mul_f32 v130, v64, v65
  ds_add_f32 v34, v130 offset:1536
  v_and_b32 v64, 0xffff0000, v119
  v_and_b32 v65, 0xffff0000, v123
  v_fma_f32 v65, s91, v51, v65
  v_add_f32 v64, v64, v65
  v_exp_f32 v65, v64
  s_nop 0
  v_add_f32 v65, 1.0, v65
  v_rcp_f32 v65, v65
  s_nop 0
  v_mul_f32 v131, v64, v65
  ds_add_f32 v34, v131 offset:1792
  s_branch k2_slow_edge
k2_slow_next:
  s_add_u32 s57, s57, 512
  s_cmp_lt_u32 s57, 160000
  s_cbranch_scc1 k2_slow_scan
  s_waitcnt lgkmcnt(0)
  s_barrier
  ds_read_b32 v60, v28 offset:2304
  s_waitcnt lgkmcnt(0)
  v_cvt_f32_u32 v60, v60
  ds_write_b32 v28, v60 offset:256
  s_add_u32 s88, s26, 0
  s_lshl_b32 s89, s88, 11
  s_add_u32 s89, s89, 4096
  v_add_u32 v34, s89, v28
  s_mul_i32 s88, s88, 1040
  s_add_u32 s88, s88, 90112
  v_add_u32 v62, s88, v4
  ds_read_b32 v124, v34 offset:0
  ds_read_b32 v125, v34 offset:256
  ds_read_b32 v126, v34 offset:512
  ds_read_b32 v127, v34 offset:768
  ds_read_b32 v128, v34 offset:1024
  ds_read_b32 v129, v34 offset:1280
  ds_read_b32 v130, v34 offset:1536
  ds_read_b32 v131, v34 offset:1792
  s_waitcnt lgkmcnt(0)
  v_cvt_pk_bf16_f32 v64, v124, v125
  v_cvt_pk_bf16_f32 v65, v126, v127
  v_cvt_pk_bf16_f32 v66, v128, v129
  v_cvt_pk_bf16_f32 v67, v130, v131
  ds_write_b128 v62, v[64:67]
  s_add_u32 s88, s26, 8
  s_lshl_b32 s89, s88, 11
  s_add_u32 s89, s89, 4096
  v_add_u32 v34, s89, v28
  s_mul_i32 s88, s88, 1040
  s_add_u32 s88, s88, 90112
  v_add_u32 v62, s88, v4
  ds_read_b32 v124, v34 offset:0
  ds_read_b32 v125, v34 offset:256
  ds_read_b32 v126, v34 offset:512
  ds_read_b32 v127, v34 offset:768
  ds_read_b32 v128, v34 offset:1024
  ds_read_b32 v129, v34 offset:1280
  ds_read_b32 v130, v34 offset:1536
  ds_read_b32 v131, v34 offset:1792
  s_waitcnt lgkmcnt(0)
  v_cvt_pk_bf16_f32 v64, v124, v125
  v_cvt_pk_bf16_f32 v65, v126, v127
  v_cvt_pk_bf16_f32 v66, v128, v129
  v_cvt_pk_bf16_f32 v67, v130, v131
  ds_write_b128 v62, v[64:67]
  s_add_u32 s88, s26, 16
  s_lshl_b32 s89, s88, 11
  s_add_u32 s89, s89, 4096
  v_add_u32 v34, s89, v28
  s_mul_i32 s88, s88, 1040
  s_add_u32 s88, s88, 90112
  v_add_u32 v62, s88, v4
  ds_read_b32 v124, v34 offset:0
  ds_read_b32 v125, v34 offset:256
  ds_read_b32 v126, v34 offset:512
  ds_read_b32 v127, v34 offset:768
  ds_read_b32 v128, v34 offset:1024
  ds_read_b32 v129, v34 offset:1280
  ds_read_b32 v130, v34 offset:1536
  ds_read_b32 v131, v34 offset:1792
  s_waitcnt lgkmcnt(0)
  v_cvt_pk_bf16_f32 v64, v124, v125
  v_cvt_pk_bf16_f32 v65, v126, v127
  v_cvt_pk_bf16_f32 v66, v128, v129
  v_cvt_pk_bf16_f32 v67, v130, v131
  ds_write_b128 v62, v[64:67]
  s_add_u32 s88, s26, 24
  s_lshl_b32 s89, s88, 11
  s_add_u32 s89, s89, 4096
  v_add_u32 v34, s89, v28
  s_mul_i32 s88, s88, 1040
  s_add_u32 s88, s88, 90112
  v_add_u32 v62, s88, v4
  ds_read_b32 v124, v34 offset:0
  ds_read_b32 v125, v34 offset:256
  ds_read_b32 v126, v34 offset:512
  ds_read_b32 v127, v34 offset:768
  ds_read_b32 v128, v34 offset:1024
  ds_read_b32 v129, v34 offset:1280
  ds_read_b32 v130, v34 offset:1536
  ds_read_b32 v131, v34 offset:1792
  s_waitcnt lgkmcnt(0)
  v_cvt_pk_bf16_f32 v64, v124, v125
  v_cvt_pk_bf16_f32 v65, v126, v127
  v_cvt_pk_bf16_f32 v66, v128, v129
  v_cvt_pk_bf16_f32 v67, v130, v131
  ds_write_b128 v62, v[64:67]
  s_add_u32 s88, s26, 32
  s_lshl_b32 s89, s88, 11
  s_add_u32 s89, s89, 4096
  v_add_u32 v34, s89, v28
  s_mul_i32 s88, s88, 1040
  s_add_u32 s88, s88, 90112
  v_add_u32 v62, s88, v4
  ds_read_b32 v124, v34 offset:0
  ds_read_b32 v125, v34 offset:256
  ds_read_b32 v126, v34 offset:512
  ds_read_b32 v127, v34 offset:768
  ds_read_b32 v128, v34 offset:1024
  ds_read_b32 v129, v34 offset:1280
  ds_read_b32 v130, v34 offset:1536
  ds_read_b32 v131, v34 offset:1792
  s_waitcnt lgkmcnt(0)
  v_cvt_pk_bf16_f32 v64, v124, v125
  v_cvt_pk_bf16_f32 v65, v126, v127
  v_cvt_pk_bf16_f32 v66, v128, v129
  v_cvt_pk_bf16_f32 v67, v130, v131
  ds_write_b128 v62, v[64:67]
  s_waitcnt lgkmcnt(0)
  s_barrier
  v_and_b32 v14, 48, v1
  ds_read_b128 v[44:47], v14 offset:256
  ds_read_b128 v[48:51], v14 offset:320
  ds_read_b128 v[52:55], v14 offset:384
  s_mov_b32 s88, 0xbfb8aa3b
  v_lshlrev_b32 v56, 16, v11
  v_and_b32 v57, 0xffff0000, v11
  v_mul_f32 v56, s88, v56
  v_mul_f32 v57, s88, v57
  s_waitcnt lgkmcnt(0)
  v_mul_f32 v180, v44, v56
  v_mul_f32 v181, v45, v56
  v_mul_f32 v182, v46, v56
  v_mul_f32 v183, v47, v56
  v_mul_f32 v184, v44, v57
  v_mul_f32 v185, v45, v57
  v_mul_f32 v186, v46, v57
  v_mul_f32 v187, v47, v57
  v_mul_f32 v188, v48, v56
  v_mul_f32 v189, v49, v56
  v_mul_f32 v190, v50, v56
  v_mul_f32 v191, v51, v56
  v_mul_f32 v192, v48, v57
  v_mul_f32 v193, v49, v57
  v_mul_f32 v194, v50, v57
  v_mul_f32 v195, v51, v57
  v_mul_f32 v196, v52, v56
  v_mul_f32 v197, v53, v56
  v_mul_f32 v198, v54, v56
  v_mul_f32 v199, v55, v56
  v_mul_f32 v200, v52, v57
  v_mul_f32 v201, v53, v57
  v_mul_f32 v202, v54, v57
  v_mul_f32 v203, v55, v57
  v_and_b32 v14, 48, v1
  ds_read_b128 v[28:31], v14 offset:0
  ds_read_b128 v[32:35], v14 offset:64
  v_and_b32 v14, 16, v1
  v_lshrrev_b32 v38, 5, v1
  v_lshl_add_u32 v14, v38, 3, v14
  ds_read_b64 v[36:37], v14 offset:128
  s_waitcnt lgkmcnt(0)
  s_mov_b32 s93, 0
  v_add_u32 v28, v28, v10
  v_add_u32 v29, v29, v10
  v_add_u32 v30, v30, v10
  v_add_u32 v31, v31, v10
  v_add_u32 v32, v32, v10
  v_add_u32 v33, v33, v10
  v_add_u32 v34, v34, v10
  v_add_u32 v35, v35, v10
  v_add_u32 v36, v36, v10
  v_add_u32 v37, v37, v10
k2_slow_gemm:
  s_add_u32 s88, s92, 0
  buffer_load_dwordx4 v[204:207], v4, s[36:39], s88 offen offset:0
  buffer_load_dwordx4 v[212:215], v4, s[36:39], s88 offen offset:1024
  buffer_load_dwordx4 v[208:211], v4, s[36:39], s88 offen offset:2048
  buffer_load_dwordx4 v[216:219], v4, s[36:39], s88 offen offset:3072
  s_add_u32 s88, s92, 4096
  buffer_load_dwordx4 v[220:223], v4, s[36:39], s88 offen offset:0
  buffer_load_dwordx4 v[228:231], v4, s[36:39], s88 offen offset:1024
  buffer_load_dwordx4 v[224:227], v4, s[36:39], s88 offen offset:2048
  buffer_load_dwordx4 v[232:235], v4, s[36:39], s88 offen offset:3072
  ds_read_b128 v[60:63], v240 offset:0
  ds_read_b128 v[64:67], v240 offset:16640
  ds_read_b128 v[68:71], v240 offset:64
  ds_read_b128 v[72:75], v240 offset:16704
  ds_read2_b32 v[236:237], v241 offset0:0 offset1:2
  ds_read2_b32 v[238:239], v241 offset0:4 offset1:6
  s_waitcnt vmcnt(0)
  s_waitcnt lgkmcnt(5)
  v_mfma_f32_16x16x32_bf16 v[180:183], v[60:63], v[204:207], v[180:183]
  v_mfma_f32_16x16x32_bf16 v[184:187], v[60:63], v[212:215], v[184:187]
  ds_read_b128 v[60:63], v240 offset:128
  s_waitcnt lgkmcnt(5)
  v_mfma_f32_16x16x32_bf16 v[188:191], v[64:67], v[204:207], v[188:191]
  v_mfma_f32_16x16x32_bf16 v[192:195], v[64:67], v[212:215], v[192:195]
  ds_read_b128 v[64:67], v240 offset:16768
  s_waitcnt lgkmcnt(5)
  v_mfma_f32_16x16x32_bf16 v[180:183], v[68:71], v[208:211], v[180:183]
  v_mfma_f32_16x16x32_bf16 v[184:187], v[68:71], v[216:219], v[184:187]
  ds_read_b128 v[68:71], v240 offset:192
  s_waitcnt lgkmcnt(5)
  v_mfma_f32_16x16x32_bf16 v[188:191], v[72:75], v[208:211], v[188:191]
  v_mfma_f32_16x16x32_bf16 v[192:195], v[72:75], v[216:219], v[192:195]
  ds_read_b128 v[72:75], v240 offset:16832
  s_waitcnt lgkmcnt(4)
  v_smfmac_f32_16x16x64_bf16 v[196:199], v[236:239], v[204:211], v242
  v_smfmac_f32_16x16x64_bf16 v[200:203], v[236:239], v[212:219], v242
  ds_read2_b32 v[236:237], v241 offset0:32 offset1:34
  ds_read2_b32 v[238:239], v241 offset0:36 offset1:38
  s_waitcnt lgkmcnt(5)
  v_mfma_f32_16x16x32_bf16 v[180:183], v[60:63], v[220:223], v[180:183]
  v_mfma_f32_16x16x32_bf16 v[184:187], v[60:63], v[228:231], v[184:187]
  s_waitcnt lgkmcnt(4)
  v_mfma_f32_16x16x32_bf16 v[188:191], v[64:67], v[220:223], v[188:191]
  v_mfma_f32_16x16x32_bf16 v[192:195], v[64:67], v[228:231], v[192:195]
  s_waitcnt lgkmcnt(3)
  v_mfma_f32_16x16x32_bf16 v[180:183], v[68:71], v[224:227], v[180:183]
  v_mfma_f32_16x16x32_bf16 v[184:187], v[68:71], v[232:235], v[184:187]
  s_waitcnt lgkmcnt(2)
  v_mfma_f32_16x16x32_bf16 v[188:191], v[72:75], v[224:227], v[188:191]
  v_mfma_f32_16x16x32_bf16 v[192:195], v[72:75], v[232:235], v[192:195]
  s_waitcnt lgkmcnt(0)
  v_smfmac_f32_16x16x64_bf16 v[196:199], v[236:239], v[220:227], v242
  v_smfmac_f32_16x16x64_bf16 v[200:203], v[236:239], v[228:235], v242
  v_add_u32 v240, 256, v240
  v_add_u32 v241, 256, v241
  s_add_u32 s92, s92, 8192
  s_add_u32 s93, s93, 1
  s_cmp_lt_u32 s93, 4
  s_cbranch_scc1 k2_slow_gemm
  s_mov_b32 s89, 0xbf317218
  s_nop 7
  v_mul_f32 v180, s89, v180
  v_mul_f32 v184, s89, v184
  v_cvt_pk_bf16_f32 v180, v180, v184
  v_mul_f32 v181, s89, v181
  v_mul_f32 v185, s89, v185
  v_cvt_pk_bf16_f32 v181, v181, v185
  buffer_store_dword v180, v28, s[40:43], 0 offen sc1
  v_mul_f32 v182, s89, v182
  v_mul_f32 v186, s89, v186
  v_cvt_pk_bf16_f32 v182, v182, v186
  buffer_store_dword v181, v29, s[40:43], 0 offen sc1
  v_mul_f32 v183, s89, v183
  v_mul_f32 v187, s89, v187
  v_cvt_pk_bf16_f32 v183, v183, v187
  buffer_store_dword v182, v30, s[40:43], 0 offen sc1
  buffer_store_dword v183, v31, s[40:43], 0 offen sc1
  v_mul_f32 v188, s89, v188
  v_mul_f32 v192, s89, v192
  v_cvt_pk_bf16_f32 v188, v188, v192
  v_mul_f32 v189, s89, v189
  v_mul_f32 v193, s89, v193
  v_cvt_pk_bf16_f32 v189, v189, v193
  buffer_store_dword v188, v32, s[40:43], 0 offen sc1
  v_mul_f32 v190, s89, v190
  v_mul_f32 v194, s89, v194
  v_cvt_pk_bf16_f32 v190, v190, v194
  buffer_store_dword v189, v33, s[40:43], 0 offen sc1
  v_mul_f32 v191, s89, v191
  v_mul_f32 v195, s89, v195
  v_cvt_pk_bf16_f32 v191, v191, v195
  buffer_store_dword v190, v34, s[40:43], 0 offen sc1
  buffer_store_dword v191, v35, s[40:43], 0 offen sc1
  v_permlane32_swap_b32 v196, v200
  v_permlane32_swap_b32 v197, v201
  v_permlane32_swap_b32 v198, v202
  v_permlane32_swap_b32 v199, v203
  v_add_f32 v196, v196, v200
  v_add_f32 v197, v197, v201
  v_add_f32 v198, v198, v202
  v_add_f32 v199, v199, v203
  v_mul_f32 v196, s89, v196
  v_mul_f32 v197, s89, v197
  v_mul_f32 v198, s89, v198
  v_mul_f32 v199, s89, v199
  s_nop 0
  v_permlane32_swap_b32 v196, v198
  v_permlane32_swap_b32 v197, v199
  v_cvt_pk_bf16_f32 v196, v196, v198
  v_cvt_pk_bf16_f32 v197, v197, v199
  buffer_store_dword v196, v36, s[40:43], 0 offen sc1
  buffer_store_dword v197, v37, s[40:43], 0 offen sc1
  s_branch k2_end
k2_exit:
  s_endpgm
mpnn_code_end:
.section .rodata,"a"
.p2align 6
.amdhsa_kernel mpnn_prep_kernel
  .amdhsa_next_free_vgpr 232
  .amdhsa_next_free_sgpr 102
  .amdhsa_accum_offset 232
  .amdhsa_group_segment_fixed_size 0
  .amdhsa_kernarg_size 88
  .amdhsa_user_sgpr_count 2
  .amdhsa_user_sgpr_kernarg_segment_ptr 1
  .amdhsa_system_sgpr_workgroup_id_x 1
  .amdhsa_float_denorm_mode_32 3
.end_amdhsa_kernel
.p2align 6
.amdhsa_kernel mpnn_edge_kernel
  .amdhsa_next_free_vgpr 248
  .amdhsa_next_free_sgpr 102
  .amdhsa_accum_offset 248
  .amdhsa_group_segment_fixed_size 0
  .amdhsa_kernarg_size 88
  .amdhsa_user_sgpr_count 2
  .amdhsa_user_sgpr_kernarg_segment_ptr 1
  .amdhsa_system_sgpr_workgroup_id_x 1
  .amdhsa_float_denorm_mode_32 3
.end_amdhsa_kernel
```
